```python
import torch

def _softmax(x, axis=-1):
    return torch.softmax(x, dim=axis)

def _gelu(x):
    return torch.nn.functional.gelu(x, approximate='tanh')

def _silu(x):
    return torch.nn.functional.silu(x)

def _sigmoid(x):
    return torch.sigmoid(x)

def _layernorm(x, axis=-1, eps=1e-05):
    m = x.mean(dim=axis, keepdim=True)
    v = x.var(dim=axis, keepdim=True, unbiased=False)
    return (x - m) / torch.sqrt(v + eps)

def _scatter_add(tgt, idx, src, axis=0):
    return tgt.clone().index_add_(axis, idx, src)

def _segment_sum(src, seg, n):
    out = torch.zeros((n,) + src.shape[1:], dtype=src.dtype)
    return out.index_add_(0, seg, src)

def _pad(x, pw):
    flat = tuple((v for pair in reversed(pw) for v in pair))
    return torch.nn.functional.pad(x, flat)
kernel_name = 'gated_mix__grouped_kv_mqa__mixer_gmlp__prompt'

def setup_inputs():

    _w = lambda a: (lambda t: t.to(torch.bfloat16) if t.is_floating_point() else t)(torch.as_tensor(a))

    def _A_setup():
        B, S, D, H = (1, 2048, 576, 32)
        Dh = D // H
        return {'x': _w((lambda *s: torch.randn(*s, dtype=torch.bfloat16) * 0.05)(B, S, D)), 'wq': _w((lambda *s: torch.randn(*s, dtype=torch.bfloat16) * 3.2)(D, H * Dh)), 'wk': _w((lambda *s: torch.randn(*s, dtype=torch.bfloat16) * 3.2)(D, Dh)), 'wv': _w((lambda *s: torch.randn(*s, dtype=torch.bfloat16) * 0.4)(D, Dh)), 'wo': _w((lambda *s: torch.randn(*s, dtype=torch.bfloat16) * 0.4)(H * Dh, D))}
    _A_in = _A_setup()

    def _B_setup():
        B, S, D, F = (1, 2048, 576, 4608)
        Fh = F // 2
        return {'x': _w((lambda *s: torch.randn(*s, dtype=torch.bfloat16) * 0.05)(B, S, D)), 'w_in': _w((lambda *s: torch.randn(*s, dtype=torch.bfloat16) * 1.6)(D, 2 * Fh)), 'w_sp': _w(0.01 * (lambda *s: torch.randn(*s, dtype=torch.bfloat16) * 1.6)(S, S)), 'b_sp': _w(1.0 + 0.01 * (lambda *s: torch.randn(*s, dtype=torch.bfloat16) * 0.1)(S)), 'w_out': _w((lambda *s: torch.randn(*s, dtype=torch.bfloat16) * 0.1)(Fh, D))}
    _B_in = _B_setup()
    return {'A_x': _A_in['x'], 'A_wq': _A_in['wq'], 'A_wk': _A_in['wk'], 'A_wv': _A_in['wv'], 'A_wo': _A_in['wo'], 'B_x': _B_in['x'], 'B_w_in': _B_in['w_in'], 'B_w_sp': _B_in['w_sp'], 'B_b_sp': _B_in['b_sp'], 'B_w_out': _B_in['w_out'], 'gate_w': _w((lambda *s: torch.randn(*s, dtype=torch.bfloat16) * 0.1)(576) * 16.0)}

def reference(A_x, A_wq, A_wk, A_wv, A_wo, B_x, B_w_in, B_w_sp, B_b_sp, B_w_out, gate_w):

    def _A_ref(x, wq, wk, wv, wo):
        B, S, D = x.shape
        H = 32
        Dh = D // H
        q = (lambda x, *d: x.permute(*d))((x @ wq).reshape(B, S, H, Dh), 0, 2, 1, 3)
        k = x @ wk
        v = x @ wv
        scores = torch.einsum('bhqd,bkd->bhqk', q, k) * Dh ** (-0.5)
        p = _softmax(scores, axis=-1)
        o = torch.einsum('bhqk,bkd->bhqd', p, v)
        return (lambda x, *d: x.permute(*d))(o, 0, 2, 1, 3).reshape(B, S, H * Dh) @ wo

    def _B_ref(x, w_in, w_sp, b_sp, w_out):
        B, S, D = x.shape
        F = w_in.shape[-1]
        Fh = F // 2
        z = _gelu(torch.einsum('bsd,df->bsf', x, w_in))
        z1 = z[..., :Fh].clone()
        z2 = _layernorm(z[..., Fh:], axis=-1)
        g = torch.einsum('ts,bsf->btf', w_sp, z2) + b_sp[None, :, None]
        return torch.einsum('bsf,fd->bsd', z1 * g, w_out)
    x = A_x
    g = _sigmoid((x * gate_w).sum(-1, keepdims=True))
    a = _A_ref(x, A_wq, A_wk, A_wv, A_wo)
    b = _B_ref(x, B_w_in, B_w_sp, B_b_sp, B_w_out)
    return g * a + (1 - g) * b
```

```asm
; @launch grid=(256,1,1) block=(512,1,1) lds=163840
.amdgcn_target "amdgcn-amd-amdhsa--gfx950"
.text
.globl gated_mix__grouped_kv_mqa__mixer_gmlp__prompt_kernel
.p2align 8
.type gated_mix__grouped_kv_mqa__mixer_gmlp__prompt_kernel,@function
gated_mix__grouped_kv_mqa__mixer_gmlp__prompt_kernel:
    s_cmp_ge_u32 s2, 256
    s_cbranch_scc1 GF_END
    s_load_dwordx8 s[8:15], s[0:1], 0
    s_load_dwordx2 s[16:17], s[0:1], 48
    s_load_dwordx2 s[18:19], s[0:1], 80
    s_load_dwordx4 s[92:95], s[0:1], 96
    v_lshrrev_b32 v1, 6, v0
    v_and_b32 v0, 63, v0
    s_and_b32 s3, s2, 7
    s_lshr_b32 s4, s2, 3
    v_readfirstlane_b32 s47, v1
    s_and_b32 s44, s3, 1
    s_lshl_b32 s44, s44, 3
    s_and_b32 s5, s4, 7
    s_add_u32 s44, s44, s5
    s_lshr_b32 s45, s3, 1
    s_lshl_b32 s45, s45, 2
    s_lshr_b32 s5, s4, 3
    s_add_u32 s45, s45, s5
    s_cmp_ge_u32 s45, 14
    s_cselect_b32 s46, 11, s45
    s_waitcnt lgkmcnt(0)
    s_mov_b32 s20, s94
    s_mov_b32 s21, s95
    s_mov_b32 s24, s8
    s_mov_b32 s25, s9
    s_mov_b32 s26, 2359296
    s_mov_b32 s27, 0x00020000
    s_mov_b32 s28, s16
    s_mov_b32 s29, s17
    s_mov_b32 s30, 5308416
    s_mov_b32 s31, 0x00020000
    s_mov_b32 s36, s20
    s_mov_b32 s37, s21
    s_mov_b32 s38, 41218048
    s_mov_b32 s39, 0x00020000
    s_mov_b32 s40, s18
    s_mov_b32 s41, s19
    s_mov_b32 s42, 1152
    s_mov_b32 s43, 0x00020000
    s_cmp_eq_u32 s46, 12
    s_cselect_b32 s32, s12, s10
    s_cselect_b32 s33, s13, s11
    s_cmp_eq_u32 s46, 13
    s_cselect_b32 s32, s14, s32
    s_cselect_b32 s33, s15, s33
    s_mov_b32 s34, 663552
    s_cmp_ge_u32 s46, 12
    s_cselect_b32 s34, 20736, s34
    s_mov_b32 s35, 0x00020000
    s_cmp_ge_u32 s47, 4
    s_cbranch_scc1 GF_LOADER
    s_lshl_b32 s3, s44, 2
    s_add_u32 s3, s3, s47
    s_lshl_b32 s5, s3, 5
    s_lshl_b32 s4, s45, 1
    s_add_u32 s5, s5, s4
    v_lshrrev_b32 v1, 5, v0
    v_add_u32 v1, s5, v1
    v_and_b32 v2, 31, v0
    v_mul_u32_u24 v2, 36, v2
    v_mul_u32_u24 v3, 1152, v1
    v_add_u32 v3, v3, v2
    buffer_load_dwordx4 v[8:11], v3, s[24:27], 0 offen
    buffer_load_dwordx4 v[12:15], v3, s[24:27], 0 offen offset:16
    buffer_load_dword v16, v3, s[24:27], 0 offen offset:32
    buffer_load_dwordx4 v[20:23], v2, s[40:43], 0 offen
    buffer_load_dwordx4 v[24:27], v2, s[40:43], 0 offen offset:16
    buffer_load_dword v28, v2, s[40:43], 0 offen offset:32
    v_lshlrev_b32 v81, 3, v1
    v_mov_b32 v44, 4947968
    s_or_b32 s63, s2, s47
    s_cmp_lg_u32 s63, 0
    s_cbranch_scc1 GF_NOTAG
    buffer_load_dword v45, v44, s[36:39], 0 offen sc1
GF_NOTAG:
    s_cmp_lg_u32 s47, 3
    s_cbranch_scc1 GF_NOCP
    s_getpc_b64 s[6:7]
GF_PC:
    s_lshr_b32 s5, s2, 3
    s_mul_i32 s5, s5, 1152
    s_add_u32 s5, s5, GF_LOOP-GF_PC
    v_min_u32 v62, 8, v0
    v_lshl_add_u32 v62, v62, 7, s5
    v_min_u32 v62, CODE_END-GF_PC, v62
    v_mov_b32 v61, s7
    v_add_co_u32 v60, vcc, s6, v62
    s_nop 1
    v_addc_co_u32 v61, vcc, 0, v61, vcc
    global_load_dword v63, v[60:61], off
GF_NOCP:
    s_cmp_lg_u32 s47, 2
    s_cbranch_scc1 GF_NOSP
    s_load_dwordx2 s[48:49], s[0:1], 56
    s_lshl_b32 s5, s44, 7
    s_lshl_b32 s6, s45, 3
    s_add_u32 s5, s5, s6
    v_bfe_u32 v60, v0, 1, 3
    v_add_u32 v60, s5, v60
    v_lshlrev_b32 v60, 12, v60
    v_and_b32 v61, 1, v0
    v_lshl_add_u32 v60, v61, 7, v60
    v_lshrrev_b32 v61, 4, v0
    v_min_u32 v61, 0, v61
    v_lshlrev_b32 v62, 2, v61
    v_subrev_u32 v62, 3, v62
    v_max_i32 v62, 0, v62
    v_add_u32 v62, s44, v62
    v_and_b32 v62, 15, v62
    v_lshl_add_u32 v60, v62, 8, v60
    s_waitcnt lgkmcnt(0)
    s_mov_b32 s50, 8388608
    s_mov_b32 s51, 0x00020000
    buffer_load_dword v63, v60, s[48:51], 0 offen
GF_NOSP:
    v_lshrrev_b32 v4, 4, v0
    v_bfe_u32 v5, v0, 2, 2
    v_and_b32 v6, 3, v0
    v_bfe_u32 v7, v0, 1, 3
    v_xor_b32 v7, v7, v4
    v_lshlrev_b32 v7, 4, v7
    v_and_b32 v30, 15, v0
    v_lshl_add_u32 v7, v30, 7, v7
    s_lshl_b32 s4, s47, 12
    v_add_u32 v52, s4, v7
    v_xor_b32 v58, 64, v52
    v_lshl_add_u32 v30, v4, 3, v5
    v_mul_u32_u24 v31, 576, v30
    v_lshl_add_u32 v31, v6, 3, v31
    v_add_u32 v31, 49152, v31
    v_and_b32 v32, 1, v4
    v_lshlrev_b32 v33, 5, v32
    v_add_u32 v53, v31, v33
    v_sub_u32 v54, v31, v33
    v_lshlrev_b32 v31, 7, v30
    v_lshl_add_u32 v31, v6, 3, v31
    v_add_u32 v31, 67584, v31
    v_lshrrev_b32 v33, 1, v5
    v_lshl_or_b32 v33, v32, 1, v33
    s_and_b32 s4, s46, 1
    s_add_u32 s5, s4, 0
    v_xor_b32 v34, s5, v33
    v_lshl_add_u32 v55, v34, 5, v31
    s_add_u32 s5, s4, 1
    v_xor_b32 v34, s5, v33
    v_lshl_add_u32 v56, v34, 5, v31
    s_add_u32 s5, s4, 2
    v_xor_b32 v34, s5, v33
    v_lshl_add_u32 v57, v34, 5, v31
    s_cmp_lt_u32 s46, 12
    s_cbranch_scc1 GF_QADDR
    v_lshlrev_b32 v31, 10, v4
    v_lshl_add_u32 v31, v5, 6, v31
    v_lshl_add_u32 v31, v6, 3, v31
    v_add_u32 v55, 67584, v31
    v_add_u32 v56, 32, v55
    v_add_u32 v57, 64, v55
GF_QADDR:
    v_mov_b32 v88, 0
    v_mov_b32 v89, 0
    v_mov_b32 v90, 0
    v_mov_b32 v91, 0
    v_mov_b32 v92, 0
    v_mov_b32 v93, 0
    v_mov_b32 v94, 0
    v_mov_b32 v95, 0
    v_mov_b32 v96, 0
    v_mov_b32 v97, 0
    v_mov_b32 v98, 0
    v_mov_b32 v99, 0
    v_mov_b32 v100, 0
    v_mov_b32 v101, 0
    v_mov_b32 v102, 0
    v_mov_b32 v103, 0
    v_mov_b32 v104, 0
    v_mov_b32 v105, 0
    v_mov_b32 v106, 0
    v_mov_b32 v107, 0
    v_mov_b32 v108, 0
    v_mov_b32 v109, 0
    v_mov_b32 v110, 0
    v_mov_b32 v111, 0
    v_mov_b32 v112, 0
    v_mov_b32 v113, 0
    v_mov_b32 v114, 0
    v_mov_b32 v115, 0
    v_mov_b32 v116, 0
    v_mov_b32 v117, 0
    v_mov_b32 v118, 0
    v_mov_b32 v119, 0
    v_mov_b32 v120, 0
    v_mov_b32 v121, 0
    v_mov_b32 v122, 0
    v_mov_b32 v123, 0
    v_mov_b32 v124, 0
    v_mov_b32 v125, 0
    v_mov_b32 v126, 0
    v_mov_b32 v127, 0
    v_mov_b32 v128, 0
    v_mov_b32 v129, 0
    v_mov_b32 v130, 0
    v_mov_b32 v131, 0
    v_mov_b32 v132, 0
    v_mov_b32 v133, 0
    v_mov_b32 v134, 0
    v_mov_b32 v135, 0
    v_mov_b32 v136, 0
    v_mov_b32 v137, 0
    v_mov_b32 v138, 0
    v_mov_b32 v139, 0
    v_mov_b32 v140, 0
    v_mov_b32 v141, 0
    v_mov_b32 v142, 0
    v_mov_b32 v143, 0
    v_mov_b32 v144, 0
    v_mov_b32 v145, 0
    v_mov_b32 v146, 0
    v_mov_b32 v147, 0
    v_mov_b32 v148, 0
    v_mov_b32 v149, 0
    v_mov_b32 v150, 0
    v_mov_b32 v151, 0
    v_mov_b32 v152, 0
    v_mov_b32 v153, 0
    v_mov_b32 v154, 0
    v_mov_b32 v155, 0
    v_mov_b32 v156, 0
    v_mov_b32 v157, 0
    v_mov_b32 v158, 0
    v_mov_b32 v159, 0
    v_mov_b32 v160, 0
    v_mov_b32 v161, 0
    v_mov_b32 v162, 0
    v_mov_b32 v163, 0
    v_mov_b32 v164, 0
    v_mov_b32 v165, 0
    v_mov_b32 v166, 0
    v_mov_b32 v167, 0
    v_mov_b32 v168, 0
    v_mov_b32 v169, 0
    v_mov_b32 v170, 0
    v_mov_b32 v171, 0
    v_mov_b32 v172, 0
    v_mov_b32 v173, 0
    v_mov_b32 v174, 0
    v_mov_b32 v175, 0
    v_mov_b32 v176, 0
    v_mov_b32 v177, 0
    v_mov_b32 v178, 0
    v_mov_b32 v179, 0
    v_mov_b32 v180, 0
    v_mov_b32 v181, 0
    v_mov_b32 v182, 0
    v_mov_b32 v183, 0
    v_mov_b32 v184, 0
    v_mov_b32 v185, 0
    v_mov_b32 v186, 0
    v_mov_b32 v187, 0
    v_mov_b32 v188, 0
    v_mov_b32 v189, 0
    v_mov_b32 v190, 0
    v_mov_b32 v191, 0
    v_mov_b32 v192, 0
    v_mov_b32 v193, 0
    v_mov_b32 v194, 0
    v_mov_b32 v195, 0
    v_mov_b32 v196, 0
    v_mov_b32 v197, 0
    v_mov_b32 v198, 0
    v_mov_b32 v199, 0
    v_mov_b32 v200, 0
    v_mov_b32 v201, 0
    v_mov_b32 v202, 0
    v_mov_b32 v203, 0
    v_mov_b32 v204, 0
    v_mov_b32 v205, 0
    v_mov_b32 v206, 0
    v_mov_b32 v207, 0
    v_mov_b32 v208, 0
    v_mov_b32 v209, 0
    v_mov_b32 v210, 0
    v_mov_b32 v211, 0
    v_mov_b32 v212, 0
    v_mov_b32 v213, 0
    v_mov_b32 v214, 0
    v_mov_b32 v215, 0
    v_mov_b32 v216, 0
    v_mov_b32 v217, 0
    v_mov_b32 v218, 0
    v_mov_b32 v219, 0
    v_mov_b32 v220, 0
    v_mov_b32 v221, 0
    v_mov_b32 v222, 0
    v_mov_b32 v223, 0
    v_mov_b32 v224, 0
    v_mov_b32 v225, 0
    v_mov_b32 v226, 0
    v_mov_b32 v227, 0
    v_mov_b32 v228, 0
    v_mov_b32 v229, 0
    v_mov_b32 v230, 0
    v_mov_b32 v231, 0
    v_mov_b32 v232, 0
    v_mov_b32 v233, 0
    v_mov_b32 v234, 0
    v_mov_b32 v235, 0
    v_mov_b32 v236, 0
    v_mov_b32 v237, 0
    v_mov_b32 v238, 0
    v_mov_b32 v239, 0
    v_mov_b32 v240, 0
    v_mov_b32 v241, 0
    v_mov_b32 v242, 0
    v_mov_b32 v243, 0
    v_mov_b32 v244, 0
    v_mov_b32 v245, 0
    v_mov_b32 v246, 0
    v_mov_b32 v247, 0
    v_mov_b32 v248, 0
    v_mov_b32 v249, 0
    v_mov_b32 v250, 0
    v_mov_b32 v251, 0
    v_mov_b32 v252, 0
    v_mov_b32 v253, 0
    v_mov_b32 v254, 0
    v_mov_b32 v255, 0
    s_waitcnt vmcnt(0)
    s_cmp_lg_u32 s63, 0
    s_cbranch_scc1 GF_NOTAG2
    s_mov_b32 s40, s92
    s_mov_b32 s41, s93
    s_mov_b32 s42, 256
    s_mov_b32 s5, 1664525
    v_mul_lo_u32 v45, v45, s5
    v_add_u32 v45, 1013904223, v45
    v_max_u32 v45, 1, v45
    v_mov_b32 v46, 0
    s_mov_b64 exec, 1
    buffer_store_dword v45, v46, s[40:43], 0 offen sc1
    buffer_store_dword v45, v44, s[36:39], 0 offen sc1
    s_mov_b64 exec, -1
GF_NOTAG2:
    v_mov_b32 v40, 0
    v_lshlrev_b32 v32, 16, v8
    v_and_b32 v33, 0xffff0000, v8
    v_lshlrev_b32 v34, 16, v20
    v_and_b32 v35, 0xffff0000, v20
    v_mul_f32 v32, v32, v34
    v_mul_f32 v33, v33, v35
    v_cvt_pk_bf16_f32 v32, v32, v33
    v_lshlrev_b32 v33, 16, v32
    v_and_b32 v32, 0xffff0000, v32
    v_add_f32 v40, v40, v33
    v_add_f32 v40, v40, v32
    v_lshlrev_b32 v32, 16, v9
    v_and_b32 v33, 0xffff0000, v9
    v_lshlrev_b32 v34, 16, v21
    v_and_b32 v35, 0xffff0000, v21
    v_mul_f32 v32, v32, v34
    v_mul_f32 v33, v33, v35
    v_cvt_pk_bf16_f32 v32, v32, v33
    v_lshlrev_b32 v33, 16, v32
    v_and_b32 v32, 0xffff0000, v32
    v_add_f32 v40, v40, v33
    v_add_f32 v40, v40, v32
    v_lshlrev_b32 v32, 16, v10
    v_and_b32 v33, 0xffff0000, v10
    v_lshlrev_b32 v34, 16, v22
    v_and_b32 v35, 0xffff0000, v22
    v_mul_f32 v32, v32, v34
    v_mul_f32 v33, v33, v35
    v_cvt_pk_bf16_f32 v32, v32, v33
    v_lshlrev_b32 v33, 16, v32
    v_and_b32 v32, 0xffff0000, v32
    v_add_f32 v40, v40, v33
    v_add_f32 v40, v40, v32
    v_lshlrev_b32 v32, 16, v11
    v_and_b32 v33, 0xffff0000, v11
    v_lshlrev_b32 v34, 16, v23
    v_and_b32 v35, 0xffff0000, v23
    v_mul_f32 v32, v32, v34
    v_mul_f32 v33, v33, v35
    v_cvt_pk_bf16_f32 v32, v32, v33
    v_lshlrev_b32 v33, 16, v32
    v_and_b32 v32, 0xffff0000, v32
    v_add_f32 v40, v40, v33
    v_add_f32 v40, v40, v32
    v_lshlrev_b32 v32, 16, v12
    v_and_b32 v33, 0xffff0000, v12
    v_lshlrev_b32 v34, 16, v24
    v_and_b32 v35, 0xffff0000, v24
    v_mul_f32 v32, v32, v34
    v_mul_f32 v33, v33, v35
    v_cvt_pk_bf16_f32 v32, v32, v33
    v_lshlrev_b32 v33, 16, v32
    v_and_b32 v32, 0xffff0000, v32
    v_add_f32 v40, v40, v33
    v_add_f32 v40, v40, v32
    v_lshlrev_b32 v32, 16, v13
    v_and_b32 v33, 0xffff0000, v13
    v_lshlrev_b32 v34, 16, v25
    v_and_b32 v35, 0xffff0000, v25
    v_mul_f32 v32, v32, v34
    v_mul_f32 v33, v33, v35
    v_cvt_pk_bf16_f32 v32, v32, v33
    v_lshlrev_b32 v33, 16, v32
    v_and_b32 v32, 0xffff0000, v32
    v_add_f32 v40, v40, v33
    v_add_f32 v40, v40, v32
    v_lshlrev_b32 v32, 16, v14
    v_and_b32 v33, 0xffff0000, v14
    v_lshlrev_b32 v34, 16, v26
    v_and_b32 v35, 0xffff0000, v26
    v_mul_f32 v32, v32, v34
    v_mul_f32 v33, v33, v35
    v_cvt_pk_bf16_f32 v32, v32, v33
    v_lshlrev_b32 v33, 16, v32
    v_and_b32 v32, 0xffff0000, v32
    v_add_f32 v40, v40, v33
    v_add_f32 v40, v40, v32
    v_lshlrev_b32 v32, 16, v15
    v_and_b32 v33, 0xffff0000, v15
    v_lshlrev_b32 v34, 16, v27
    v_and_b32 v35, 0xffff0000, v27
    v_mul_f32 v32, v32, v34
    v_mul_f32 v33, v33, v35
    v_cvt_pk_bf16_f32 v32, v32, v33
    v_lshlrev_b32 v33, 16, v32
    v_and_b32 v32, 0xffff0000, v32
    v_add_f32 v40, v40, v33
    v_add_f32 v40, v40, v32
    v_lshlrev_b32 v32, 16, v16
    v_and_b32 v33, 0xffff0000, v16
    v_lshlrev_b32 v34, 16, v28
    v_and_b32 v35, 0xffff0000, v28
    v_mul_f32 v32, v32, v34
    v_mul_f32 v33, v33, v35
    v_cvt_pk_bf16_f32 v32, v32, v33
    v_lshlrev_b32 v33, 16, v32
    v_and_b32 v32, 0xffff0000, v32
    v_add_f32 v40, v40, v33
    v_add_f32 v40, v40, v32
    s_nop 1
    v_add_f32_dpp v40, v40, v40 row_ror:8 row_mask:0xf bank_mask:0xf
    s_nop 1
    v_add_f32_dpp v40, v40, v40 row_ror:4 row_mask:0xf bank_mask:0xf
    s_nop 1
    v_add_f32_dpp v40, v40, v40 row_ror:2 row_mask:0xf bank_mask:0xf
    s_nop 1
    v_add_f32_dpp v40, v40, v40 row_ror:1 row_mask:0xf bank_mask:0xf
    v_mov_b32 v41, v40
    s_nop 1
    v_permlane16_swap_b32 v40, v41
    v_add_f32 v40, v40, v41
    v_cvt_pk_bf16_f32 v40, v40, v40
    v_and_b32 v40, 0xffff0000, v40
    v_mul_f32 v40, 0xbfb8aa3b, v40
    v_exp_f32 v40, v40
    s_nop 0
    v_add_f32 v40, 1.0, v40
    v_rcp_f32 v40, v40
    s_nop 0
    v_cvt_pk_bf16_f32 v40, v40, v40
    v_and_b32 v86, 0xffff0000, v40
    v_sub_f32 v41, 1.0, v86
    v_cvt_pk_bf16_f32 v41, v41, v41
    v_and_b32 v87, 0xffff0000, v41
    s_mov_b32 s50, 0
    s_mov_b32 s52, 9
    s_mov_b32 s53, 22528
    s_mov_b32 s48, 0
    s_mov_b32 s54, 16384
    s_barrier
    ds_read_b64_tr_b16 v[24:25], v53 offset:0
    ds_read_b128 v[8:11], v52 offset:0
    ds_read_b64_tr_b16 v[26:27], v53 offset:2304
    ds_read_b64_tr_b16 v[28:29], v54 offset:32
    ds_read_b128 v[12:15], v52 offset:2048
    ds_read_b64_tr_b16 v[30:31], v54 offset:2336
    ds_read_b64_tr_b16 v[32:33], v53 offset:64
    ds_read_b64_tr_b16 v[34:35], v53 offset:2368
    ds_read_b64_tr_b16 v[36:37], v54 offset:96
    ds_read_b64_tr_b16 v[38:39], v54 offset:2400
    ds_read_b64_tr_b16 v[40:41], v53 offset:128
    ds_read_b64_tr_b16 v[42:43], v53 offset:2432
GF_LOOP:
    s_waitcnt lgkmcnt(7)
    v_mfma_f32_16x16x32_bf16 v[88:91], v[8:11], v[24:27], v[88:91]
    ds_read_b64_tr_b16 v[44:45], v54 offset:160
    v_mfma_f32_16x16x32_bf16 v[92:95], v[12:15], v[24:27], v[92:95]
    ds_read_b64_tr_b16 v[46:47], v54 offset:2464
    s_waitcnt lgkmcnt(8)
    v_mfma_f32_16x16x32_bf16 v[96:99], v[8:11], v[28:31], v[96:99]
    ds_read_b64_tr_b16 v[48:49], v53 offset:192
    s_add_u32 s50, s50, 1
    s_cmp_eq_u32 s50, 5
    v_mfma_f32_16x16x32_bf16 v[100:103], v[12:15], v[28:31], v[100:103]
    ds_read_b64_tr_b16 v[50:51], v53 offset:2496
    s_waitcnt lgkmcnt(8)
    v_mfma_f32_16x16x32_bf16 v[104:107], v[8:11], v[32:35], v[104:107]
    ds_read_b64_tr_b16 v[24:25], v54 offset:224
    s_cselect_b32 s51, 4294877184, s53
    s_cselect_b32 s50, 0, s50
    v_mfma_f32_16x16x32_bf16 v[108:111], v[12:15], v[32:35], v[108:111]
    ds_read_b64_tr_b16 v[26:27], v54 offset:2528
    s_waitcnt lgkmcnt(8)
    v_mfma_f32_16x16x32_bf16 v[112:115], v[8:11], v[36:39], v[112:115]
    ds_read_b64_tr_b16 v[28:29], v53 offset:256
    v_mfma_f32_16x16x32_bf16 v[116:119], v[12:15], v[36:39], v[116:119]
    ds_read_b64_tr_b16 v[30:31], v53 offset:2560
    s_waitcnt lgkmcnt(8)
    v_mfma_f32_16x16x32_bf16 v[120:123], v[8:11], v[40:43], v[120:123]
    ds_read_b64_tr_b16 v[32:33], v54 offset:288
    v_mfma_f32_16x16x32_bf16 v[124:127], v[12:15], v[40:43], v[124:127]
    ds_read_b64_tr_b16 v[34:35], v54 offset:2592
    s_waitcnt lgkmcnt(8)
    v_mfma_f32_16x16x32_bf16 v[128:131], v[8:11], v[44:47], v[128:131]
    ds_read_b64_tr_b16 v[36:37], v53 offset:320
    v_mfma_f32_16x16x32_bf16 v[132:135], v[12:15], v[44:47], v[132:135]
    ds_read_b64_tr_b16 v[38:39], v53 offset:2624
    s_waitcnt lgkmcnt(8)
    v_mfma_f32_16x16x32_bf16 v[136:139], v[8:11], v[48:51], v[136:139]
    ds_read_b64_tr_b16 v[40:41], v54 offset:352
    v_mfma_f32_16x16x32_bf16 v[140:143], v[12:15], v[48:51], v[140:143]
    ds_read_b64_tr_b16 v[42:43], v54 offset:2656
    s_waitcnt lgkmcnt(8)
    v_mfma_f32_16x16x32_bf16 v[144:147], v[8:11], v[24:27], v[144:147]
    ds_read_b64_tr_b16 v[44:45], v53 offset:384
    v_mfma_f32_16x16x32_bf16 v[148:151], v[12:15], v[24:27], v[148:151]
    ds_read_b64_tr_b16 v[46:47], v53 offset:2688
    s_waitcnt lgkmcnt(8)
    v_mfma_f32_16x16x32_bf16 v[152:155], v[8:11], v[28:31], v[152:155]
    ds_read_b64_tr_b16 v[48:49], v54 offset:416
    v_mfma_f32_16x16x32_bf16 v[156:159], v[12:15], v[28:31], v[156:159]
    ds_read_b64_tr_b16 v[50:51], v54 offset:2720
    s_waitcnt lgkmcnt(8)
    v_mfma_f32_16x16x32_bf16 v[160:163], v[8:11], v[32:35], v[160:163]
    ds_read_b64_tr_b16 v[24:25], v53 offset:448
    v_mfma_f32_16x16x32_bf16 v[164:167], v[12:15], v[32:35], v[164:167]
    ds_read_b64_tr_b16 v[26:27], v53 offset:2752
    s_waitcnt lgkmcnt(8)
    v_mfma_f32_16x16x32_bf16 v[168:171], v[8:11], v[36:39], v[168:171]
    ds_read_b64_tr_b16 v[28:29], v54 offset:480
    v_mfma_f32_16x16x32_bf16 v[172:175], v[12:15], v[36:39], v[172:175]
    ds_read_b64_tr_b16 v[30:31], v54 offset:2784
    s_waitcnt lgkmcnt(8)
    v_mfma_f32_16x16x32_bf16 v[176:179], v[8:11], v[40:43], v[176:179]
    ds_read_b64_tr_b16 v[32:33], v53 offset:512
    v_mfma_f32_16x16x32_bf16 v[180:183], v[12:15], v[40:43], v[180:183]
    ds_read_b64_tr_b16 v[34:35], v53 offset:2816
    s_waitcnt lgkmcnt(8)
    v_mfma_f32_16x16x32_bf16 v[184:187], v[8:11], v[44:47], v[184:187]
    ds_read_b64_tr_b16 v[36:37], v54 offset:544
    v_add_u32 v53, s51, v53
    v_mfma_f32_16x16x32_bf16 v[188:191], v[12:15], v[44:47], v[188:191]
    ds_read_b64_tr_b16 v[38:39], v54 offset:2848
    s_waitcnt lgkmcnt(8)
    v_mfma_f32_16x16x32_bf16 v[192:195], v[8:11], v[48:51], v[192:195]
    ds_read_b64_tr_b16 v[40:41], v55 offset:0
    v_add_u32 v54, s51, v54
    v_mfma_f32_16x16x32_bf16 v[196:199], v[12:15], v[48:51], v[196:199]
    ds_read_b64_tr_b16 v[42:43], v55 offset:512
    s_waitcnt lgkmcnt(8)
    v_mfma_f32_16x16x32_bf16 v[200:203], v[8:11], v[24:27], v[200:203]
    ds_read_b64_tr_b16 v[44:45], v56 offset:0
    v_add_u32 v55, s51, v55
    v_mfma_f32_16x16x32_bf16 v[204:207], v[12:15], v[24:27], v[204:207]
    ds_read_b64_tr_b16 v[46:47], v56 offset:512
    s_waitcnt lgkmcnt(8)
    v_mfma_f32_16x16x32_bf16 v[208:211], v[8:11], v[28:31], v[208:211]
    ds_read_b64_tr_b16 v[48:49], v57 offset:0
    v_add_u32 v56, s51, v56
    v_mfma_f32_16x16x32_bf16 v[212:215], v[12:15], v[28:31], v[212:215]
    ds_read_b64_tr_b16 v[50:51], v57 offset:512
    s_waitcnt lgkmcnt(8)
    v_mfma_f32_16x16x32_bf16 v[216:219], v[8:11], v[32:35], v[216:219]
    s_barrier
    ds_read_b64_tr_b16 v[24:25], v53 offset:0
    ds_read_b128 v[16:19], v58 offset:0
    v_add_u32 v57, s51, v57
    v_mfma_f32_16x16x32_bf16 v[220:223], v[12:15], v[32:35], v[220:223]
    ds_read_b64_tr_b16 v[26:27], v53 offset:2304
    s_waitcnt lgkmcnt(9)
    v_mfma_f32_16x16x32_bf16 v[224:227], v[8:11], v[36:39], v[224:227]
    ds_read_b64_tr_b16 v[28:29], v54 offset:32
    ds_read_b128 v[20:23], v58 offset:2048
    v_mfma_f32_16x16x32_bf16 v[228:231], v[12:15], v[36:39], v[228:231]
    ds_read_b64_tr_b16 v[30:31], v54 offset:2336
    s_waitcnt lgkmcnt(10)
    v_mfma_f32_16x16x32_bf16 v[232:235], v[40:43], v[8:11], v[232:235]
    ds_read_b64_tr_b16 v[32:33], v53 offset:64
    v_mfma_f32_16x16x32_bf16 v[236:239], v[40:43], v[12:15], v[236:239]
    ds_read_b64_tr_b16 v[34:35], v53 offset:2368
    s_waitcnt lgkmcnt(10)
    v_mfma_f32_16x16x32_bf16 v[240:243], v[44:47], v[8:11], v[240:243]
    ds_read_b64_tr_b16 v[36:37], v54 offset:96
    v_mfma_f32_16x16x32_bf16 v[244:247], v[44:47], v[12:15], v[244:247]
    ds_read_b64_tr_b16 v[38:39], v54 offset:2400
    s_waitcnt lgkmcnt(10)
    v_mfma_f32_16x16x32_bf16 v[248:251], v[48:51], v[8:11], v[248:251]
    ds_read_b64_tr_b16 v[40:41], v53 offset:128
    v_mfma_f32_16x16x32_bf16 v[252:255], v[48:51], v[12:15], v[252:255]
    ds_read_b64_tr_b16 v[42:43], v53 offset:2432
    s_waitcnt lgkmcnt(7)
    v_mfma_f32_16x16x32_bf16 v[88:91], v[16:19], v[24:27], v[88:91]
    ds_read_b64_tr_b16 v[44:45], v54 offset:160
    v_mfma_f32_16x16x32_bf16 v[92:95], v[20:23], v[24:27], v[92:95]
    ds_read_b64_tr_b16 v[46:47], v54 offset:2464
    s_waitcnt lgkmcnt(8)
    v_mfma_f32_16x16x32_bf16 v[96:99], v[16:19], v[28:31], v[96:99]
    ds_read_b64_tr_b16 v[48:49], v53 offset:192
    s_add_u32 s50, s50, 1
    s_cmp_eq_u32 s50, 5
    v_mfma_f32_16x16x32_bf16 v[100:103], v[20:23], v[28:31], v[100:103]
    ds_read_b64_tr_b16 v[50:51], v53 offset:2496
    s_waitcnt lgkmcnt(8)
    v_mfma_f32_16x16x32_bf16 v[104:107], v[16:19], v[32:35], v[104:107]
    ds_read_b64_tr_b16 v[24:25], v54 offset:224
    s_cselect_b32 s51, 4294877184, s53
    s_cselect_b32 s50, 0, s50
    v_mfma_f32_16x16x32_bf16 v[108:111], v[20:23], v[32:35], v[108:111]
    ds_read_b64_tr_b16 v[26:27], v54 offset:2528
    s_waitcnt lgkmcnt(8)
    v_mfma_f32_16x16x32_bf16 v[112:115], v[16:19], v[36:39], v[112:115]
    ds_read_b64_tr_b16 v[28:29], v53 offset:256
    v_mfma_f32_16x16x32_bf16 v[116:119], v[20:23], v[36:39], v[116:119]
    ds_read_b64_tr_b16 v[30:31], v53 offset:2560
    s_waitcnt lgkmcnt(8)
    v_mfma_f32_16x16x32_bf16 v[120:123], v[16:19], v[40:43], v[120:123]
    ds_read_b64_tr_b16 v[32:33], v54 offset:288
    s_add_u32 s48, s48, 1
    s_cmp_eq_u32 s48, 3
    v_mfma_f32_16x16x32_bf16 v[124:127], v[20:23], v[40:43], v[124:127]
    ds_read_b64_tr_b16 v[34:35], v54 offset:2592
    s_waitcnt lgkmcnt(8)
    v_mfma_f32_16x16x32_bf16 v[128:131], v[16:19], v[44:47], v[128:131]
    ds_read_b64_tr_b16 v[36:37], v53 offset:320
    s_cselect_b32 s49, 4294934528, s54
    s_cselect_b32 s48, 0, s48
    v_mfma_f32_16x16x32_bf16 v[132:135], v[20:23], v[44:47], v[132:135]
    ds_read_b64_tr_b16 v[38:39], v53 offset:2624
    s_waitcnt lgkmcnt(8)
    v_mfma_f32_16x16x32_bf16 v[136:139], v[16:19], v[48:51], v[136:139]
    ds_read_b64_tr_b16 v[40:41], v54 offset:352
    v_add_u32 v52, s49, v52
    v_mfma_f32_16x16x32_bf16 v[140:143], v[20:23], v[48:51], v[140:143]
    ds_read_b64_tr_b16 v[42:43], v54 offset:2656
    s_waitcnt lgkmcnt(8)
    v_mfma_f32_16x16x32_bf16 v[144:147], v[16:19], v[24:27], v[144:147]
    ds_read_b64_tr_b16 v[44:45], v53 offset:384
    v_add_u32 v58, s49, v58
    v_mfma_f32_16x16x32_bf16 v[148:151], v[20:23], v[24:27], v[148:151]
    ds_read_b64_tr_b16 v[46:47], v53 offset:2688
    s_waitcnt lgkmcnt(8)
    v_mfma_f32_16x16x32_bf16 v[152:155], v[16:19], v[28:31], v[152:155]
    ds_read_b64_tr_b16 v[48:49], v54 offset:416
    v_mfma_f32_16x16x32_bf16 v[156:159], v[20:23], v[28:31], v[156:159]
    ds_read_b64_tr_b16 v[50:51], v54 offset:2720
    s_waitcnt lgkmcnt(8)
    v_mfma_f32_16x16x32_bf16 v[160:163], v[16:19], v[32:35], v[160:163]
    ds_read_b64_tr_b16 v[24:25], v53 offset:448
    v_mfma_f32_16x16x32_bf16 v[164:167], v[20:23], v[32:35], v[164:167]
    ds_read_b64_tr_b16 v[26:27], v53 offset:2752
    s_waitcnt lgkmcnt(8)
    v_mfma_f32_16x16x32_bf16 v[168:171], v[16:19], v[36:39], v[168:171]
    ds_read_b64_tr_b16 v[28:29], v54 offset:480
    v_mfma_f32_16x16x32_bf16 v[172:175], v[20:23], v[36:39], v[172:175]
    ds_read_b64_tr_b16 v[30:31], v54 offset:2784
    s_waitcnt lgkmcnt(8)
    v_mfma_f32_16x16x32_bf16 v[176:179], v[16:19], v[40:43], v[176:179]
    ds_read_b64_tr_b16 v[32:33], v53 offset:512
    v_mfma_f32_16x16x32_bf16 v[180:183], v[20:23], v[40:43], v[180:183]
    ds_read_b64_tr_b16 v[34:35], v53 offset:2816
    s_waitcnt lgkmcnt(8)
    v_mfma_f32_16x16x32_bf16 v[184:187], v[16:19], v[44:47], v[184:187]
    ds_read_b64_tr_b16 v[36:37], v54 offset:544
    v_add_u32 v53, s51, v53
    v_mfma_f32_16x16x32_bf16 v[188:191], v[20:23], v[44:47], v[188:191]
    ds_read_b64_tr_b16 v[38:39], v54 offset:2848
    s_waitcnt lgkmcnt(8)
    v_mfma_f32_16x16x32_bf16 v[192:195], v[16:19], v[48:51], v[192:195]
    ds_read_b64_tr_b16 v[40:41], v55 offset:0
    v_add_u32 v54, s51, v54
    v_mfma_f32_16x16x32_bf16 v[196:199], v[20:23], v[48:51], v[196:199]
    ds_read_b64_tr_b16 v[42:43], v55 offset:512
    s_waitcnt lgkmcnt(8)
    v_mfma_f32_16x16x32_bf16 v[200:203], v[16:19], v[24:27], v[200:203]
    ds_read_b64_tr_b16 v[44:45], v56 offset:0
    v_add_u32 v55, s51, v55
    v_mfma_f32_16x16x32_bf16 v[204:207], v[20:23], v[24:27], v[204:207]
    ds_read_b64_tr_b16 v[46:47], v56 offset:512
    s_waitcnt lgkmcnt(8)
    v_mfma_f32_16x16x32_bf16 v[208:211], v[16:19], v[28:31], v[208:211]
    ds_read_b64_tr_b16 v[48:49], v57 offset:0
    v_add_u32 v56, s51, v56
    v_mfma_f32_16x16x32_bf16 v[212:215], v[20:23], v[28:31], v[212:215]
    ds_read_b64_tr_b16 v[50:51], v57 offset:512
    s_waitcnt lgkmcnt(8)
    v_mfma_f32_16x16x32_bf16 v[216:219], v[16:19], v[32:35], v[216:219]
    s_barrier
    ds_read_b64_tr_b16 v[24:25], v53 offset:0
    ds_read_b128 v[8:11], v52 offset:0
    v_add_u32 v57, s51, v57
    v_mfma_f32_16x16x32_bf16 v[220:223], v[20:23], v[32:35], v[220:223]
    ds_read_b64_tr_b16 v[26:27], v53 offset:2304
    s_waitcnt lgkmcnt(9)
    v_mfma_f32_16x16x32_bf16 v[224:227], v[16:19], v[36:39], v[224:227]
    ds_read_b64_tr_b16 v[28:29], v54 offset:32
    ds_read_b128 v[12:15], v52 offset:2048
    v_mfma_f32_16x16x32_bf16 v[228:231], v[20:23], v[36:39], v[228:231]
    ds_read_b64_tr_b16 v[30:31], v54 offset:2336
    s_waitcnt lgkmcnt(10)
    v_mfma_f32_16x16x32_bf16 v[232:235], v[40:43], v[16:19], v[232:235]
    ds_read_b64_tr_b16 v[32:33], v53 offset:64
    v_mfma_f32_16x16x32_bf16 v[236:239], v[40:43], v[20:23], v[236:239]
    ds_read_b64_tr_b16 v[34:35], v53 offset:2368
    s_waitcnt lgkmcnt(10)
    v_mfma_f32_16x16x32_bf16 v[240:243], v[44:47], v[16:19], v[240:243]
    ds_read_b64_tr_b16 v[36:37], v54 offset:96
    v_mfma_f32_16x16x32_bf16 v[244:247], v[44:47], v[20:23], v[244:247]
    ds_read_b64_tr_b16 v[38:39], v54 offset:2400
    s_waitcnt lgkmcnt(10)
    v_mfma_f32_16x16x32_bf16 v[248:251], v[48:51], v[16:19], v[248:251]
    ds_read_b64_tr_b16 v[40:41], v53 offset:128
    v_mfma_f32_16x16x32_bf16 v[252:255], v[48:51], v[20:23], v[252:255]
    ds_read_b64_tr_b16 v[42:43], v53 offset:2432
    s_sub_u32 s52, s52, 1
    s_cmp_lg_u32 s52, 0
    s_cbranch_scc1 GF_LOOP
    s_waitcnt lgkmcnt(0)
    s_setprio 2
    v_mov_b32 v15, 161792
    ds_read_b32 v15, v15
    s_lshl_b32 s5, s47, 8
    s_add_u32 s5, s5, 39936
    s_cmp_ge_u32 s47, 4
    s_cselect_b32 s6, 39936, 0
    s_add_u32 s5, s5, s6
    v_lshl_add_u32 v84, v0, 2, s5
    v_mov_b32 v85, 0
    v_mov_b32 v82, 2
    s_waitcnt lgkmcnt(0)
    s_barrier
    ds_write_b32 v84, v82
    v_lshlrev_b32 v83, 2, v0
    v_add_u32 v83, 162816, v83
    ds_write_b32 v83, v85
    s_mul_i32 s5, s47, 7168
    s_add_u32 s5, s5, 81920
    v_lshl_add_u32 v1, v0, 4, s5
    ds_write_b128 v1, v[232:235] offset:0
    ds_write_b128 v1, v[236:239] offset:1024
    ds_write_b128 v1, v[240:243] offset:2048
    ds_write_b128 v1, v[244:247] offset:3072
    ds_write_b128 v1, v[248:251] offset:4096
    ds_write_b128 v1, v[252:255] offset:5120
    ds_write_b64 v1, v[86:87] offset:6144
    s_waitcnt lgkmcnt(0)
    v_mov_b32 v85, 1
    s_barrier
    s_load_dwordx4 s[8:11], s[0:1], 56
    s_load_dwordx2 s[12:13], s[0:1], 72
    s_load_dwordx2 s[16:17], s[0:1], 32
    s_mov_b64 exec, -1
    v_mov_b32 v8, 0xc0135761
    v_mov_b32 v9, 0xc0135761
    v_mov_b32 v10, 0xbdd2d3e8
    v_mov_b32 v11, 0xbdd2d3e8
    v_mov_b32 v12, 1.0
    v_mov_b32 v13, 1.0
    v_lshlrev_b32 v1, 4, v0
    v_mov_b32 v3, 0
    v_pk_mul_f32 v[32:33], v[152:153], v[152:153]
    v_pk_mul_f32 v[34:35], v[154:155], v[154:155]
    v_pk_mul_f32 v[36:37], v[156:157], v[156:157]
    v_pk_mul_f32 v[38:39], v[158:159], v[158:159]
    v_pk_fma_f32 v[32:33], v[32:33], v[10:11], v[8:9]
    v_pk_fma_f32 v[34:35], v[34:35], v[10:11], v[8:9]
    v_pk_fma_f32 v[36:37], v[36:37], v[10:11], v[8:9]
    v_pk_fma_f32 v[38:39], v[38:39], v[10:11], v[8:9]
    v_pk_mul_f32 v[32:33], v[32:33], v[152:153]
    v_pk_mul_f32 v[34:35], v[34:35], v[154:155]
    v_pk_mul_f32 v[36:37], v[36:37], v[156:157]
    v_pk_mul_f32 v[38:39], v[38:39], v[158:159]
    v_exp_f32 v32, v32
    v_exp_f32 v33, v33
    v_exp_f32 v34, v34
    v_exp_f32 v35, v35
    v_exp_f32 v36, v36
    v_exp_f32 v37, v37
    v_exp_f32 v38, v38
    v_exp_f32 v39, v39
    v_pk_add_f32 v[32:33], v[32:33], v[12:13]
    v_pk_add_f32 v[34:35], v[34:35], v[12:13]
    v_pk_add_f32 v[36:37], v[36:37], v[12:13]
    v_pk_add_f32 v[38:39], v[38:39], v[12:13]
    v_rcp_f32 v32, v32
    v_rcp_f32 v33, v33
    v_rcp_f32 v34, v34
    v_rcp_f32 v35, v35
    v_rcp_f32 v36, v36
    v_rcp_f32 v37, v37
    v_rcp_f32 v38, v38
    v_rcp_f32 v39, v39
    v_pk_mul_f32 v[152:153], v[32:33], v[152:153]
    v_pk_mul_f32 v[154:155], v[34:35], v[154:155]
    v_pk_mul_f32 v[156:157], v[36:37], v[156:157]
    v_pk_mul_f32 v[158:159], v[38:39], v[158:159]
    v_mov_b32 v16, v152
    v_mov_b32 v17, v153
    v_mov_b32 v18, v154
    v_mov_b32 v19, v155
    v_mov_b32 v20, v156
    v_mov_b32 v21, v157
    v_mov_b32 v22, v158
    v_mov_b32 v23, v159
    v_pk_mul_f32 v[24:25], v[152:153], v[152:153]
    v_pk_mul_f32 v[26:27], v[154:155], v[154:155]
    v_pk_mul_f32 v[28:29], v[156:157], v[156:157]
    v_pk_mul_f32 v[30:31], v[158:159], v[158:159]
    v_pk_mul_f32 v[40:41], v[160:161], v[160:161]
    v_pk_mul_f32 v[42:43], v[162:163], v[162:163]
    v_pk_mul_f32 v[44:45], v[164:165], v[164:165]
    v_pk_mul_f32 v[46:47], v[166:167], v[166:167]
    v_pk_fma_f32 v[40:41], v[40:41], v[10:11], v[8:9]
    v_pk_fma_f32 v[42:43], v[42:43], v[10:11], v[8:9]
    v_pk_fma_f32 v[44:45], v[44:45], v[10:11], v[8:9]
    v_pk_fma_f32 v[46:47], v[46:47], v[10:11], v[8:9]
    v_pk_mul_f32 v[40:41], v[40:41], v[160:161]
    v_pk_mul_f32 v[42:43], v[42:43], v[162:163]
    v_pk_mul_f32 v[44:45], v[44:45], v[164:165]
    v_pk_mul_f32 v[46:47], v[46:47], v[166:167]
    v_exp_f32 v40, v40
    v_exp_f32 v41, v41
    v_exp_f32 v42, v42
    v_exp_f32 v43, v43
    v_exp_f32 v44, v44
    v_exp_f32 v45, v45
    v_exp_f32 v46, v46
    v_exp_f32 v47, v47
    v_pk_add_f32 v[40:41], v[40:41], v[12:13]
    v_pk_add_f32 v[42:43], v[42:43], v[12:13]
    v_pk_add_f32 v[44:45], v[44:45], v[12:13]
    v_pk_add_f32 v[46:47], v[46:47], v[12:13]
    v_rcp_f32 v40, v40
    v_rcp_f32 v41, v41
    v_rcp_f32 v42, v42
    v_rcp_f32 v43, v43
    v_rcp_f32 v44, v44
    v_rcp_f32 v45, v45
    v_rcp_f32 v46, v46
    v_rcp_f32 v47, v47
    v_pk_mul_f32 v[160:161], v[40:41], v[160:161]
    v_pk_mul_f32 v[162:163], v[42:43], v[162:163]
    v_pk_mul_f32 v[164:165], v[44:45], v[164:165]
    v_pk_mul_f32 v[166:167], v[46:47], v[166:167]
    v_pk_add_f32 v[16:17], v[16:17], v[160:161]
    v_pk_add_f32 v[18:19], v[18:19], v[162:163]
    v_pk_add_f32 v[20:21], v[20:21], v[164:165]
    v_pk_add_f32 v[22:23], v[22:23], v[166:167]
    v_pk_fma_f32 v[24:25], v[160:161], v[160:161], v[24:25]
    v_pk_fma_f32 v[26:27], v[162:163], v[162:163], v[26:27]
    v_pk_fma_f32 v[28:29], v[164:165], v[164:165], v[28:29]
    v_pk_fma_f32 v[30:31], v[166:167], v[166:167], v[30:31]
    v_pk_mul_f32 v[32:33], v[168:169], v[168:169]
    v_pk_mul_f32 v[34:35], v[170:171], v[170:171]
    v_pk_mul_f32 v[36:37], v[172:173], v[172:173]
    v_pk_mul_f32 v[38:39], v[174:175], v[174:175]
    v_pk_fma_f32 v[32:33], v[32:33], v[10:11], v[8:9]
    v_pk_fma_f32 v[34:35], v[34:35], v[10:11], v[8:9]
    v_pk_fma_f32 v[36:37], v[36:37], v[10:11], v[8:9]
    v_pk_fma_f32 v[38:39], v[38:39], v[10:11], v[8:9]
    v_pk_mul_f32 v[32:33], v[32:33], v[168:169]
    v_pk_mul_f32 v[34:35], v[34:35], v[170:171]
    v_pk_mul_f32 v[36:37], v[36:37], v[172:173]
    v_pk_mul_f32 v[38:39], v[38:39], v[174:175]
    v_exp_f32 v32, v32
    v_exp_f32 v33, v33
    v_exp_f32 v34, v34
    v_exp_f32 v35, v35
    v_exp_f32 v36, v36
    v_exp_f32 v37, v37
    v_exp_f32 v38, v38
    v_exp_f32 v39, v39
    v_pk_add_f32 v[32:33], v[32:33], v[12:13]
    v_pk_add_f32 v[34:35], v[34:35], v[12:13]
    v_pk_add_f32 v[36:37], v[36:37], v[12:13]
    v_pk_add_f32 v[38:39], v[38:39], v[12:13]
    v_rcp_f32 v32, v32
    v_rcp_f32 v33, v33
    v_rcp_f32 v34, v34
    v_rcp_f32 v35, v35
    v_rcp_f32 v36, v36
    v_rcp_f32 v37, v37
    v_rcp_f32 v38, v38
    v_rcp_f32 v39, v39
    v_pk_mul_f32 v[168:169], v[32:33], v[168:169]
    v_pk_mul_f32 v[170:171], v[34:35], v[170:171]
    v_pk_mul_f32 v[172:173], v[36:37], v[172:173]
    v_pk_mul_f32 v[174:175], v[38:39], v[174:175]
    v_pk_add_f32 v[16:17], v[16:17], v[168:169]
    v_pk_add_f32 v[18:19], v[18:19], v[170:171]
    v_pk_add_f32 v[20:21], v[20:21], v[172:173]
    v_pk_add_f32 v[22:23], v[22:23], v[174:175]
    v_pk_fma_f32 v[24:25], v[168:169], v[168:169], v[24:25]
    v_pk_fma_f32 v[26:27], v[170:171], v[170:171], v[26:27]
    v_pk_fma_f32 v[28:29], v[172:173], v[172:173], v[28:29]
    v_pk_fma_f32 v[30:31], v[174:175], v[174:175], v[30:31]
    v_pk_mul_f32 v[40:41], v[176:177], v[176:177]
    v_pk_mul_f32 v[42:43], v[178:179], v[178:179]
    v_pk_mul_f32 v[44:45], v[180:181], v[180:181]
    v_pk_mul_f32 v[46:47], v[182:183], v[182:183]
    v_pk_fma_f32 v[40:41], v[40:41], v[10:11], v[8:9]
    v_pk_fma_f32 v[42:43], v[42:43], v[10:11], v[8:9]
    v_pk_fma_f32 v[44:45], v[44:45], v[10:11], v[8:9]
    v_pk_fma_f32 v[46:47], v[46:47], v[10:11], v[8:9]
    v_pk_mul_f32 v[40:41], v[40:41], v[176:177]
    v_pk_mul_f32 v[42:43], v[42:43], v[178:179]
    v_pk_mul_f32 v[44:45], v[44:45], v[180:181]
    v_pk_mul_f32 v[46:47], v[46:47], v[182:183]
    v_exp_f32 v40, v40
    v_exp_f32 v41, v41
    v_exp_f32 v42, v42
    v_exp_f32 v43, v43
    v_exp_f32 v44, v44
    v_exp_f32 v45, v45
    v_exp_f32 v46, v46
    v_exp_f32 v47, v47
    v_pk_add_f32 v[40:41], v[40:41], v[12:13]
    v_pk_add_f32 v[42:43], v[42:43], v[12:13]
    v_pk_add_f32 v[44:45], v[44:45], v[12:13]
    v_pk_add_f32 v[46:47], v[46:47], v[12:13]
    v_rcp_f32 v40, v40
    v_rcp_f32 v41, v41
    v_rcp_f32 v42, v42
    v_rcp_f32 v43, v43
    v_rcp_f32 v44, v44
    v_rcp_f32 v45, v45
    v_rcp_f32 v46, v46
    v_rcp_f32 v47, v47
    v_pk_mul_f32 v[176:177], v[40:41], v[176:177]
    v_pk_mul_f32 v[178:179], v[42:43], v[178:179]
    v_pk_mul_f32 v[180:181], v[44:45], v[180:181]
    v_pk_mul_f32 v[182:183], v[46:47], v[182:183]
    v_pk_add_f32 v[16:17], v[16:17], v[176:177]
    v_pk_add_f32 v[18:19], v[18:19], v[178:179]
    v_pk_add_f32 v[20:21], v[20:21], v[180:181]
    v_pk_add_f32 v[22:23], v[22:23], v[182:183]
    v_pk_fma_f32 v[24:25], v[176:177], v[176:177], v[24:25]
    v_pk_fma_f32 v[26:27], v[178:179], v[178:179], v[26:27]
    v_pk_fma_f32 v[28:29], v[180:181], v[180:181], v[28:29]
    v_pk_fma_f32 v[30:31], v[182:183], v[182:183], v[30:31]
    v_pk_mul_f32 v[32:33], v[184:185], v[184:185]
    v_pk_mul_f32 v[34:35], v[186:187], v[186:187]
    v_pk_mul_f32 v[36:37], v[188:189], v[188:189]
    v_pk_mul_f32 v[38:39], v[190:191], v[190:191]
    v_pk_fma_f32 v[32:33], v[32:33], v[10:11], v[8:9]
    v_pk_fma_f32 v[34:35], v[34:35], v[10:11], v[8:9]
    v_pk_fma_f32 v[36:37], v[36:37], v[10:11], v[8:9]
    v_pk_fma_f32 v[38:39], v[38:39], v[10:11], v[8:9]
    v_pk_mul_f32 v[32:33], v[32:33], v[184:185]
    v_pk_mul_f32 v[34:35], v[34:35], v[186:187]
    v_pk_mul_f32 v[36:37], v[36:37], v[188:189]
    v_pk_mul_f32 v[38:39], v[38:39], v[190:191]
    v_exp_f32 v32, v32
    v_exp_f32 v33, v33
    v_exp_f32 v34, v34
    v_exp_f32 v35, v35
    v_exp_f32 v36, v36
    v_exp_f32 v37, v37
    v_exp_f32 v38, v38
    v_exp_f32 v39, v39
    v_pk_add_f32 v[32:33], v[32:33], v[12:13]
    v_pk_add_f32 v[34:35], v[34:35], v[12:13]
    v_pk_add_f32 v[36:37], v[36:37], v[12:13]
    v_pk_add_f32 v[38:39], v[38:39], v[12:13]
    v_rcp_f32 v32, v32
    v_rcp_f32 v33, v33
    v_rcp_f32 v34, v34
    v_rcp_f32 v35, v35
    v_rcp_f32 v36, v36
    v_rcp_f32 v37, v37
    v_rcp_f32 v38, v38
    v_rcp_f32 v39, v39
    v_pk_mul_f32 v[184:185], v[32:33], v[184:185]
    v_pk_mul_f32 v[186:187], v[34:35], v[186:187]
    v_pk_mul_f32 v[188:189], v[36:37], v[188:189]
    v_pk_mul_f32 v[190:191], v[38:39], v[190:191]
    v_pk_add_f32 v[16:17], v[16:17], v[184:185]
    v_pk_add_f32 v[18:19], v[18:19], v[186:187]
    v_pk_add_f32 v[20:21], v[20:21], v[188:189]
    v_pk_add_f32 v[22:23], v[22:23], v[190:191]
    v_pk_fma_f32 v[24:25], v[184:185], v[184:185], v[24:25]
    v_pk_fma_f32 v[26:27], v[186:187], v[186:187], v[26:27]
    v_pk_fma_f32 v[28:29], v[188:189], v[188:189], v[28:29]
    v_pk_fma_f32 v[30:31], v[190:191], v[190:191], v[30:31]
    v_pk_mul_f32 v[40:41], v[192:193], v[192:193]
    v_pk_mul_f32 v[42:43], v[194:195], v[194:195]
    v_pk_mul_f32 v[44:45], v[196:197], v[196:197]
    v_pk_mul_f32 v[46:47], v[198:199], v[198:199]
    v_pk_fma_f32 v[40:41], v[40:41], v[10:11], v[8:9]
    v_pk_fma_f32 v[42:43], v[42:43], v[10:11], v[8:9]
    v_pk_fma_f32 v[44:45], v[44:45], v[10:11], v[8:9]
    v_pk_fma_f32 v[46:47], v[46:47], v[10:11], v[8:9]
    v_pk_mul_f32 v[40:41], v[40:41], v[192:193]
    v_pk_mul_f32 v[42:43], v[42:43], v[194:195]
    v_pk_mul_f32 v[44:45], v[44:45], v[196:197]
    v_pk_mul_f32 v[46:47], v[46:47], v[198:199]
    v_exp_f32 v40, v40
    v_exp_f32 v41, v41
    v_exp_f32 v42, v42
    v_exp_f32 v43, v43
    v_exp_f32 v44, v44
    v_exp_f32 v45, v45
    v_exp_f32 v46, v46
    v_exp_f32 v47, v47
    v_pk_add_f32 v[40:41], v[40:41], v[12:13]
    v_pk_add_f32 v[42:43], v[42:43], v[12:13]
    v_pk_add_f32 v[44:45], v[44:45], v[12:13]
    v_pk_add_f32 v[46:47], v[46:47], v[12:13]
    v_rcp_f32 v40, v40
    v_rcp_f32 v41, v41
    v_rcp_f32 v42, v42
    v_rcp_f32 v43, v43
    v_rcp_f32 v44, v44
    v_rcp_f32 v45, v45
    v_rcp_f32 v46, v46
    v_rcp_f32 v47, v47
    v_pk_mul_f32 v[192:193], v[40:41], v[192:193]
    v_pk_mul_f32 v[194:195], v[42:43], v[194:195]
    v_pk_mul_f32 v[196:197], v[44:45], v[196:197]
    v_pk_mul_f32 v[198:199], v[46:47], v[198:199]
    v_pk_add_f32 v[16:17], v[16:17], v[192:193]
    v_pk_add_f32 v[18:19], v[18:19], v[194:195]
    v_pk_add_f32 v[20:21], v[20:21], v[196:197]
    v_pk_add_f32 v[22:23], v[22:23], v[198:199]
    v_pk_fma_f32 v[24:25], v[192:193], v[192:193], v[24:25]
    v_pk_fma_f32 v[26:27], v[194:195], v[194:195], v[26:27]
    v_pk_fma_f32 v[28:29], v[196:197], v[196:197], v[28:29]
    v_pk_fma_f32 v[30:31], v[198:199], v[198:199], v[30:31]
    v_pk_mul_f32 v[32:33], v[200:201], v[200:201]
    v_pk_mul_f32 v[34:35], v[202:203], v[202:203]
    v_pk_mul_f32 v[36:37], v[204:205], v[204:205]
    v_pk_mul_f32 v[38:39], v[206:207], v[206:207]
    v_pk_fma_f32 v[32:33], v[32:33], v[10:11], v[8:9]
    v_pk_fma_f32 v[34:35], v[34:35], v[10:11], v[8:9]
    v_pk_fma_f32 v[36:37], v[36:37], v[10:11], v[8:9]
    v_pk_fma_f32 v[38:39], v[38:39], v[10:11], v[8:9]
    v_pk_mul_f32 v[32:33], v[32:33], v[200:201]
    v_pk_mul_f32 v[34:35], v[34:35], v[202:203]
    v_pk_mul_f32 v[36:37], v[36:37], v[204:205]
    v_pk_mul_f32 v[38:39], v[38:39], v[206:207]
    v_exp_f32 v32, v32
    v_exp_f32 v33, v33
    v_exp_f32 v34, v34
    v_exp_f32 v35, v35
    v_exp_f32 v36, v36
    v_exp_f32 v37, v37
    v_exp_f32 v38, v38
    v_exp_f32 v39, v39
    v_pk_add_f32 v[32:33], v[32:33], v[12:13]
    v_pk_add_f32 v[34:35], v[34:35], v[12:13]
    v_pk_add_f32 v[36:37], v[36:37], v[12:13]
    v_pk_add_f32 v[38:39], v[38:39], v[12:13]
    v_rcp_f32 v32, v32
    v_rcp_f32 v33, v33
    v_rcp_f32 v34, v34
    v_rcp_f32 v35, v35
    v_rcp_f32 v36, v36
    v_rcp_f32 v37, v37
    v_rcp_f32 v38, v38
    v_rcp_f32 v39, v39
    v_pk_mul_f32 v[200:201], v[32:33], v[200:201]
    v_pk_mul_f32 v[202:203], v[34:35], v[202:203]
    v_pk_mul_f32 v[204:205], v[36:37], v[204:205]
    v_pk_mul_f32 v[206:207], v[38:39], v[206:207]
    v_pk_add_f32 v[16:17], v[16:17], v[200:201]
    v_pk_add_f32 v[18:19], v[18:19], v[202:203]
    v_pk_add_f32 v[20:21], v[20:21], v[204:205]
    v_pk_add_f32 v[22:23], v[22:23], v[206:207]
    v_pk_fma_f32 v[24:25], v[200:201], v[200:201], v[24:25]
    v_pk_fma_f32 v[26:27], v[202:203], v[202:203], v[26:27]
    v_pk_fma_f32 v[28:29], v[204:205], v[204:205], v[28:29]
    v_pk_fma_f32 v[30:31], v[206:207], v[206:207], v[30:31]
    v_pk_mul_f32 v[40:41], v[208:209], v[208:209]
    v_pk_mul_f32 v[42:43], v[210:211], v[210:211]
    v_pk_mul_f32 v[44:45], v[212:213], v[212:213]
    v_pk_mul_f32 v[46:47], v[214:215], v[214:215]
    v_pk_fma_f32 v[40:41], v[40:41], v[10:11], v[8:9]
    v_pk_fma_f32 v[42:43], v[42:43], v[10:11], v[8:9]
    v_pk_fma_f32 v[44:45], v[44:45], v[10:11], v[8:9]
    v_pk_fma_f32 v[46:47], v[46:47], v[10:11], v[8:9]
    v_pk_mul_f32 v[40:41], v[40:41], v[208:209]
    v_pk_mul_f32 v[42:43], v[42:43], v[210:211]
    v_pk_mul_f32 v[44:45], v[44:45], v[212:213]
    v_pk_mul_f32 v[46:47], v[46:47], v[214:215]
    v_exp_f32 v40, v40
    v_exp_f32 v41, v41
    v_exp_f32 v42, v42
    v_exp_f32 v43, v43
    v_exp_f32 v44, v44
    v_exp_f32 v45, v45
    v_exp_f32 v46, v46
    v_exp_f32 v47, v47
    v_pk_add_f32 v[40:41], v[40:41], v[12:13]
    v_pk_add_f32 v[42:43], v[42:43], v[12:13]
    v_pk_add_f32 v[44:45], v[44:45], v[12:13]
    v_pk_add_f32 v[46:47], v[46:47], v[12:13]
    v_rcp_f32 v40, v40
    v_rcp_f32 v41, v41
    v_rcp_f32 v42, v42
    v_rcp_f32 v43, v43
    v_rcp_f32 v44, v44
    v_rcp_f32 v45, v45
    v_rcp_f32 v46, v46
    v_rcp_f32 v47, v47
    v_pk_mul_f32 v[208:209], v[40:41], v[208:209]
    v_pk_mul_f32 v[210:211], v[42:43], v[210:211]
    v_pk_mul_f32 v[212:213], v[44:45], v[212:213]
    v_pk_mul_f32 v[214:215], v[46:47], v[214:215]
    v_pk_add_f32 v[16:17], v[16:17], v[208:209]
    v_pk_add_f32 v[18:19], v[18:19], v[210:211]
    v_pk_add_f32 v[20:21], v[20:21], v[212:213]
    v_pk_add_f32 v[22:23], v[22:23], v[214:215]
    v_pk_fma_f32 v[24:25], v[208:209], v[208:209], v[24:25]
    v_pk_fma_f32 v[26:27], v[210:211], v[210:211], v[26:27]
    v_pk_fma_f32 v[28:29], v[212:213], v[212:213], v[28:29]
    v_pk_fma_f32 v[30:31], v[214:215], v[214:215], v[30:31]
    v_pk_mul_f32 v[32:33], v[224:225], v[224:225]
    v_pk_mul_f32 v[34:35], v[226:227], v[226:227]
    v_pk_mul_f32 v[36:37], v[228:229], v[228:229]
    v_pk_mul_f32 v[38:39], v[230:231], v[230:231]
    v_pk_fma_f32 v[32:33], v[32:33], v[10:11], v[8:9]
    v_pk_fma_f32 v[34:35], v[34:35], v[10:11], v[8:9]
    v_pk_fma_f32 v[36:37], v[36:37], v[10:11], v[8:9]
    v_pk_fma_f32 v[38:39], v[38:39], v[10:11], v[8:9]
    v_pk_mul_f32 v[32:33], v[32:33], v[224:225]
    v_pk_mul_f32 v[34:35], v[34:35], v[226:227]
    v_pk_mul_f32 v[36:37], v[36:37], v[228:229]
    v_pk_mul_f32 v[38:39], v[38:39], v[230:231]
    v_exp_f32 v32, v32
    v_exp_f32 v33, v33
    v_exp_f32 v34, v34
    v_exp_f32 v35, v35
    v_exp_f32 v36, v36
    v_exp_f32 v37, v37
    v_exp_f32 v38, v38
    v_exp_f32 v39, v39
    v_pk_add_f32 v[32:33], v[32:33], v[12:13]
    v_pk_add_f32 v[34:35], v[34:35], v[12:13]
    v_pk_add_f32 v[36:37], v[36:37], v[12:13]
    v_pk_add_f32 v[38:39], v[38:39], v[12:13]
    v_rcp_f32 v32, v32
    v_rcp_f32 v33, v33
    v_rcp_f32 v34, v34
    v_rcp_f32 v35, v35
    v_rcp_f32 v36, v36
    v_rcp_f32 v37, v37
    v_rcp_f32 v38, v38
    v_rcp_f32 v39, v39
    v_pk_mul_f32 v[224:225], v[32:33], v[224:225]
    v_pk_mul_f32 v[226:227], v[34:35], v[226:227]
    v_pk_mul_f32 v[228:229], v[36:37], v[228:229]
    v_pk_mul_f32 v[230:231], v[38:39], v[230:231]
    v_pk_add_f32 v[16:17], v[16:17], v[224:225]
    v_pk_add_f32 v[18:19], v[18:19], v[226:227]
    v_pk_add_f32 v[20:21], v[20:21], v[228:229]
    v_pk_add_f32 v[22:23], v[22:23], v[230:231]
    v_pk_fma_f32 v[24:25], v[224:225], v[224:225], v[24:25]
    v_pk_fma_f32 v[26:27], v[226:227], v[226:227], v[26:27]
    v_pk_fma_f32 v[28:29], v[228:229], v[228:229], v[28:29]
    v_pk_fma_f32 v[30:31], v[230:231], v[230:231], v[30:31]
    v_add_f32_dpp v16, v16, v16 row_ror:8 row_mask:0xf bank_mask:0xf
    v_add_f32_dpp v17, v17, v17 row_ror:8 row_mask:0xf bank_mask:0xf
    v_add_f32_dpp v18, v18, v18 row_ror:8 row_mask:0xf bank_mask:0xf
    v_add_f32_dpp v19, v19, v19 row_ror:8 row_mask:0xf bank_mask:0xf
    v_add_f32_dpp v20, v20, v20 row_ror:8 row_mask:0xf bank_mask:0xf
    v_add_f32_dpp v21, v21, v21 row_ror:8 row_mask:0xf bank_mask:0xf
    v_add_f32_dpp v22, v22, v22 row_ror:8 row_mask:0xf bank_mask:0xf
    v_add_f32_dpp v23, v23, v23 row_ror:8 row_mask:0xf bank_mask:0xf
    v_add_f32_dpp v24, v24, v24 row_ror:8 row_mask:0xf bank_mask:0xf
    v_add_f32_dpp v25, v25, v25 row_ror:8 row_mask:0xf bank_mask:0xf
    v_add_f32_dpp v26, v26, v26 row_ror:8 row_mask:0xf bank_mask:0xf
    v_add_f32_dpp v27, v27, v27 row_ror:8 row_mask:0xf bank_mask:0xf
    v_add_f32_dpp v28, v28, v28 row_ror:8 row_mask:0xf bank_mask:0xf
    v_add_f32_dpp v29, v29, v29 row_ror:8 row_mask:0xf bank_mask:0xf
    v_add_f32_dpp v30, v30, v30 row_ror:8 row_mask:0xf bank_mask:0xf
    v_add_f32_dpp v31, v31, v31 row_ror:8 row_mask:0xf bank_mask:0xf
    v_add_f32_dpp v16, v16, v16 row_ror:4 row_mask:0xf bank_mask:0xf
    v_add_f32_dpp v17, v17, v17 row_ror:4 row_mask:0xf bank_mask:0xf
    v_add_f32_dpp v18, v18, v18 row_ror:4 row_mask:0xf bank_mask:0xf
    v_add_f32_dpp v19, v19, v19 row_ror:4 row_mask:0xf bank_mask:0xf
    v_add_f32_dpp v20, v20, v20 row_ror:4 row_mask:0xf bank_mask:0xf
    v_add_f32_dpp v21, v21, v21 row_ror:4 row_mask:0xf bank_mask:0xf
    v_add_f32_dpp v22, v22, v22 row_ror:4 row_mask:0xf bank_mask:0xf
    v_add_f32_dpp v23, v23, v23 row_ror:4 row_mask:0xf bank_mask:0xf
    v_add_f32_dpp v24, v24, v24 row_ror:4 row_mask:0xf bank_mask:0xf
    v_add_f32_dpp v25, v25, v25 row_ror:4 row_mask:0xf bank_mask:0xf
    v_add_f32_dpp v26, v26, v26 row_ror:4 row_mask:0xf bank_mask:0xf
    v_add_f32_dpp v27, v27, v27 row_ror:4 row_mask:0xf bank_mask:0xf
    v_add_f32_dpp v28, v28, v28 row_ror:4 row_mask:0xf bank_mask:0xf
    v_add_f32_dpp v29, v29, v29 row_ror:4 row_mask:0xf bank_mask:0xf
    v_add_f32_dpp v30, v30, v30 row_ror:4 row_mask:0xf bank_mask:0xf
    v_add_f32_dpp v31, v31, v31 row_ror:4 row_mask:0xf bank_mask:0xf
    v_add_f32_dpp v16, v16, v16 row_ror:2 row_mask:0xf bank_mask:0xf
    v_add_f32_dpp v17, v17, v17 row_ror:2 row_mask:0xf bank_mask:0xf
    v_add_f32_dpp v18, v18, v18 row_ror:2 row_mask:0xf bank_mask:0xf
    v_add_f32_dpp v19, v19, v19 row_ror:2 row_mask:0xf bank_mask:0xf
    v_add_f32_dpp v20, v20, v20 row_ror:2 row_mask:0xf bank_mask:0xf
    v_add_f32_dpp v21, v21, v21 row_ror:2 row_mask:0xf bank_mask:0xf
    v_add_f32_dpp v22, v22, v22 row_ror:2 row_mask:0xf bank_mask:0xf
    v_add_f32_dpp v23, v23, v23 row_ror:2 row_mask:0xf bank_mask:0xf
    v_add_f32_dpp v24, v24, v24 row_ror:2 row_mask:0xf bank_mask:0xf
    v_add_f32_dpp v25, v25, v25 row_ror:2 row_mask:0xf bank_mask:0xf
    v_add_f32_dpp v26, v26, v26 row_ror:2 row_mask:0xf bank_mask:0xf
    v_add_f32_dpp v27, v27, v27 row_ror:2 row_mask:0xf bank_mask:0xf
    v_add_f32_dpp v28, v28, v28 row_ror:2 row_mask:0xf bank_mask:0xf
    v_add_f32_dpp v29, v29, v29 row_ror:2 row_mask:0xf bank_mask:0xf
    v_add_f32_dpp v30, v30, v30 row_ror:2 row_mask:0xf bank_mask:0xf
    v_add_f32_dpp v31, v31, v31 row_ror:2 row_mask:0xf bank_mask:0xf
    v_add_f32_dpp v16, v16, v16 row_ror:1 row_mask:0xf bank_mask:0xf
    v_add_f32_dpp v17, v17, v17 row_ror:1 row_mask:0xf bank_mask:0xf
    v_add_f32_dpp v18, v18, v18 row_ror:1 row_mask:0xf bank_mask:0xf
    v_add_f32_dpp v19, v19, v19 row_ror:1 row_mask:0xf bank_mask:0xf
    v_add_f32_dpp v20, v20, v20 row_ror:1 row_mask:0xf bank_mask:0xf
    v_add_f32_dpp v21, v21, v21 row_ror:1 row_mask:0xf bank_mask:0xf
    v_add_f32_dpp v22, v22, v22 row_ror:1 row_mask:0xf bank_mask:0xf
    v_add_f32_dpp v23, v23, v23 row_ror:1 row_mask:0xf bank_mask:0xf
    v_add_f32_dpp v24, v24, v24 row_ror:1 row_mask:0xf bank_mask:0xf
    v_add_f32_dpp v25, v25, v25 row_ror:1 row_mask:0xf bank_mask:0xf
    v_add_f32_dpp v26, v26, v26 row_ror:1 row_mask:0xf bank_mask:0xf
    v_add_f32_dpp v27, v27, v27 row_ror:1 row_mask:0xf bank_mask:0xf
    v_add_f32_dpp v28, v28, v28 row_ror:1 row_mask:0xf bank_mask:0xf
    v_add_f32_dpp v29, v29, v29 row_ror:1 row_mask:0xf bank_mask:0xf
    v_add_f32_dpp v30, v30, v30 row_ror:1 row_mask:0xf bank_mask:0xf
    v_add_f32_dpp v31, v31, v31 row_ror:1 row_mask:0xf bank_mask:0xf
    s_mov_b32 s58, 0x00010001
    s_mov_b32 s59, 0x00010001
    s_lshl_b64 s[58:59], s[58:59], 1
    v_cndmask_b32 v16, v16, v17, s[58:59]
    s_lshl_b64 s[58:59], s[58:59], 1
    v_cndmask_b32 v16, v16, v18, s[58:59]
    s_lshl_b64 s[58:59], s[58:59], 1
    v_cndmask_b32 v16, v16, v19, s[58:59]
    s_lshl_b64 s[58:59], s[58:59], 1
    v_cndmask_b32 v16, v16, v20, s[58:59]
    s_lshl_b64 s[58:59], s[58:59], 1
    v_cndmask_b32 v16, v16, v21, s[58:59]
    s_lshl_b64 s[58:59], s[58:59], 1
    v_cndmask_b32 v16, v16, v22, s[58:59]
    s_lshl_b64 s[58:59], s[58:59], 1
    v_cndmask_b32 v16, v16, v23, s[58:59]
    s_lshl_b64 s[58:59], s[58:59], 1
    v_cndmask_b32 v16, v16, v24, s[58:59]
    s_lshl_b64 s[58:59], s[58:59], 1
    v_cndmask_b32 v16, v16, v25, s[58:59]
    s_lshl_b64 s[58:59], s[58:59], 1
    v_cndmask_b32 v16, v16, v26, s[58:59]
    s_lshl_b64 s[58:59], s[58:59], 1
    v_cndmask_b32 v16, v16, v27, s[58:59]
    s_lshl_b64 s[58:59], s[58:59], 1
    v_cndmask_b32 v16, v16, v28, s[58:59]
    s_lshl_b64 s[58:59], s[58:59], 1
    v_cndmask_b32 v16, v16, v29, s[58:59]
    s_lshl_b64 s[58:59], s[58:59], 1
    v_cndmask_b32 v16, v16, v30, s[58:59]
    s_lshl_b64 s[58:59], s[58:59], 1
    v_cndmask_b32 v16, v16, v31, s[58:59]
    s_lshl_b32 s60, s3, 13
    s_add_u32 s60, s60, 4980736
    s_lshl_b32 s4, s45, 9
    s_add_u32 s4, s4, s60
    s_add_u32 s61, s60, 4096
    v_lshlrev_b32 v14, 3, v0
    v_mov_b32 v17, v15
    buffer_store_dwordx2 v[16:17], v14, s[36:39], s4 offen sc1
    s_mov_b32 s62, 0
    v_pk_mul_f32 v[32:33], v[88:89], v[88:89]
    v_pk_mul_f32 v[34:35], v[90:91], v[90:91]
    v_pk_mul_f32 v[36:37], v[92:93], v[92:93]
    v_pk_mul_f32 v[38:39], v[94:95], v[94:95]
    v_pk_fma_f32 v[32:33], v[32:33], v[10:11], v[8:9]
    v_pk_fma_f32 v[34:35], v[34:35], v[10:11], v[8:9]
    v_pk_fma_f32 v[36:37], v[36:37], v[10:11], v[8:9]
    v_pk_fma_f32 v[38:39], v[38:39], v[10:11], v[8:9]
    v_pk_mul_f32 v[32:33], v[32:33], v[88:89]
    v_pk_mul_f32 v[34:35], v[34:35], v[90:91]
    v_pk_mul_f32 v[36:37], v[36:37], v[92:93]
    v_pk_mul_f32 v[38:39], v[38:39], v[94:95]
    v_exp_f32 v32, v32
    v_exp_f32 v33, v33
    v_exp_f32 v34, v34
    v_exp_f32 v35, v35
    v_exp_f32 v36, v36
    v_exp_f32 v37, v37
    v_exp_f32 v38, v38
    v_exp_f32 v39, v39
    v_pk_add_f32 v[32:33], v[32:33], v[12:13]
    v_pk_add_f32 v[34:35], v[34:35], v[12:13]
    v_pk_add_f32 v[36:37], v[36:37], v[12:13]
    v_pk_add_f32 v[38:39], v[38:39], v[12:13]
    v_rcp_f32 v32, v32
    v_rcp_f32 v33, v33
    v_rcp_f32 v34, v34
    v_rcp_f32 v35, v35
    v_rcp_f32 v36, v36
    v_rcp_f32 v37, v37
    v_rcp_f32 v38, v38
    v_rcp_f32 v39, v39
    v_pk_mul_f32 v[88:89], v[32:33], v[88:89]
    v_pk_mul_f32 v[90:91], v[34:35], v[90:91]
    v_pk_mul_f32 v[92:93], v[36:37], v[92:93]
    v_pk_mul_f32 v[94:95], v[38:39], v[94:95]
    v_pk_mul_f32 v[40:41], v[96:97], v[96:97]
    v_pk_mul_f32 v[42:43], v[98:99], v[98:99]
    v_pk_mul_f32 v[44:45], v[100:101], v[100:101]
    v_pk_mul_f32 v[46:47], v[102:103], v[102:103]
    v_pk_fma_f32 v[40:41], v[40:41], v[10:11], v[8:9]
    v_pk_fma_f32 v[42:43], v[42:43], v[10:11], v[8:9]
    v_pk_fma_f32 v[44:45], v[44:45], v[10:11], v[8:9]
    v_pk_fma_f32 v[46:47], v[46:47], v[10:11], v[8:9]
    v_pk_mul_f32 v[40:41], v[40:41], v[96:97]
    v_pk_mul_f32 v[42:43], v[42:43], v[98:99]
    v_pk_mul_f32 v[44:45], v[44:45], v[100:101]
    v_pk_mul_f32 v[46:47], v[46:47], v[102:103]
    v_exp_f32 v40, v40
    v_exp_f32 v41, v41
    v_exp_f32 v42, v42
    v_exp_f32 v43, v43
    v_exp_f32 v44, v44
    v_exp_f32 v45, v45
    v_exp_f32 v46, v46
    v_exp_f32 v47, v47
    v_pk_add_f32 v[40:41], v[40:41], v[12:13]
    v_pk_add_f32 v[42:43], v[42:43], v[12:13]
    v_pk_add_f32 v[44:45], v[44:45], v[12:13]
    v_pk_add_f32 v[46:47], v[46:47], v[12:13]
    v_rcp_f32 v40, v40
    v_rcp_f32 v41, v41
    v_rcp_f32 v42, v42
    v_rcp_f32 v43, v43
    v_rcp_f32 v44, v44
    v_rcp_f32 v45, v45
    v_rcp_f32 v46, v46
    v_rcp_f32 v47, v47
    v_pk_mul_f32 v[96:97], v[40:41], v[96:97]
    v_pk_mul_f32 v[98:99], v[42:43], v[98:99]
    v_pk_mul_f32 v[100:101], v[44:45], v[100:101]
    v_pk_mul_f32 v[102:103], v[46:47], v[102:103]
    v_pk_mul_f32 v[32:33], v[104:105], v[104:105]
    v_pk_mul_f32 v[34:35], v[106:107], v[106:107]
    v_pk_mul_f32 v[36:37], v[108:109], v[108:109]
    v_pk_mul_f32 v[38:39], v[110:111], v[110:111]
    v_pk_fma_f32 v[32:33], v[32:33], v[10:11], v[8:9]
    v_pk_fma_f32 v[34:35], v[34:35], v[10:11], v[8:9]
    v_pk_fma_f32 v[36:37], v[36:37], v[10:11], v[8:9]
    v_pk_fma_f32 v[38:39], v[38:39], v[10:11], v[8:9]
    v_pk_mul_f32 v[32:33], v[32:33], v[104:105]
    v_pk_mul_f32 v[34:35], v[34:35], v[106:107]
    v_pk_mul_f32 v[36:37], v[36:37], v[108:109]
    v_pk_mul_f32 v[38:39], v[38:39], v[110:111]
    v_exp_f32 v32, v32
    v_exp_f32 v33, v33
    v_exp_f32 v34, v34
    v_exp_f32 v35, v35
    v_exp_f32 v36, v36
    v_exp_f32 v37, v37
    v_exp_f32 v38, v38
    v_exp_f32 v39, v39
    v_pk_add_f32 v[32:33], v[32:33], v[12:13]
    v_pk_add_f32 v[34:35], v[34:35], v[12:13]
    v_pk_add_f32 v[36:37], v[36:37], v[12:13]
    v_pk_add_f32 v[38:39], v[38:39], v[12:13]
    v_rcp_f32 v32, v32
    v_rcp_f32 v33, v33
    v_rcp_f32 v34, v34
    v_rcp_f32 v35, v35
    v_rcp_f32 v36, v36
    v_rcp_f32 v37, v37
    v_rcp_f32 v38, v38
    v_rcp_f32 v39, v39
    v_pk_mul_f32 v[104:105], v[32:33], v[104:105]
    v_pk_mul_f32 v[106:107], v[34:35], v[106:107]
    v_pk_mul_f32 v[108:109], v[36:37], v[108:109]
    v_pk_mul_f32 v[110:111], v[38:39], v[110:111]
    v_pk_mul_f32 v[40:41], v[112:113], v[112:113]
    v_pk_mul_f32 v[42:43], v[114:115], v[114:115]
    v_pk_mul_f32 v[44:45], v[116:117], v[116:117]
    v_pk_mul_f32 v[46:47], v[118:119], v[118:119]
    v_pk_fma_f32 v[40:41], v[40:41], v[10:11], v[8:9]
    v_pk_fma_f32 v[42:43], v[42:43], v[10:11], v[8:9]
    v_pk_fma_f32 v[44:45], v[44:45], v[10:11], v[8:9]
    v_pk_fma_f32 v[46:47], v[46:47], v[10:11], v[8:9]
    v_pk_mul_f32 v[40:41], v[40:41], v[112:113]
    v_pk_mul_f32 v[42:43], v[42:43], v[114:115]
    v_pk_mul_f32 v[44:45], v[44:45], v[116:117]
    v_pk_mul_f32 v[46:47], v[46:47], v[118:119]
    v_exp_f32 v40, v40
    v_exp_f32 v41, v41
    v_exp_f32 v42, v42
    v_exp_f32 v43, v43
    v_exp_f32 v44, v44
    v_exp_f32 v45, v45
    v_exp_f32 v46, v46
    v_exp_f32 v47, v47
    v_pk_add_f32 v[40:41], v[40:41], v[12:13]
    v_pk_add_f32 v[42:43], v[42:43], v[12:13]
    v_pk_add_f32 v[44:45], v[44:45], v[12:13]
    v_pk_add_f32 v[46:47], v[46:47], v[12:13]
    v_rcp_f32 v40, v40
    v_rcp_f32 v41, v41
    v_rcp_f32 v42, v42
    v_rcp_f32 v43, v43
    v_rcp_f32 v44, v44
    v_rcp_f32 v45, v45
    v_rcp_f32 v46, v46
    v_rcp_f32 v47, v47
    v_pk_mul_f32 v[112:113], v[40:41], v[112:113]
    v_pk_mul_f32 v[114:115], v[42:43], v[114:115]
    v_pk_mul_f32 v[116:117], v[44:45], v[116:117]
    v_pk_mul_f32 v[118:119], v[46:47], v[118:119]
    v_pk_mul_f32 v[32:33], v[120:121], v[120:121]
    v_pk_mul_f32 v[34:35], v[122:123], v[122:123]
    v_pk_mul_f32 v[36:37], v[124:125], v[124:125]
    v_pk_mul_f32 v[38:39], v[126:127], v[126:127]
    v_pk_fma_f32 v[32:33], v[32:33], v[10:11], v[8:9]
    v_pk_fma_f32 v[34:35], v[34:35], v[10:11], v[8:9]
    v_pk_fma_f32 v[36:37], v[36:37], v[10:11], v[8:9]
    v_pk_fma_f32 v[38:39], v[38:39], v[10:11], v[8:9]
    v_pk_mul_f32 v[32:33], v[32:33], v[120:121]
    v_pk_mul_f32 v[34:35], v[34:35], v[122:123]
    v_pk_mul_f32 v[36:37], v[36:37], v[124:125]
    v_pk_mul_f32 v[38:39], v[38:39], v[126:127]
    v_exp_f32 v32, v32
    v_exp_f32 v33, v33
    v_exp_f32 v34, v34
    v_exp_f32 v35, v35
    v_exp_f32 v36, v36
    v_exp_f32 v37, v37
    v_exp_f32 v38, v38
    v_exp_f32 v39, v39
    v_pk_add_f32 v[32:33], v[32:33], v[12:13]
    v_pk_add_f32 v[34:35], v[34:35], v[12:13]
    v_pk_add_f32 v[36:37], v[36:37], v[12:13]
    v_pk_add_f32 v[38:39], v[38:39], v[12:13]
    v_rcp_f32 v32, v32
    v_rcp_f32 v33, v33
    v_rcp_f32 v34, v34
    v_rcp_f32 v35, v35
    v_rcp_f32 v36, v36
    v_rcp_f32 v37, v37
    v_rcp_f32 v38, v38
    v_rcp_f32 v39, v39
    v_pk_mul_f32 v[120:121], v[32:33], v[120:121]
    v_pk_mul_f32 v[122:123], v[34:35], v[122:123]
    v_pk_mul_f32 v[124:125], v[36:37], v[124:125]
    v_pk_mul_f32 v[126:127], v[38:39], v[126:127]
    v_pk_mul_f32 v[40:41], v[128:129], v[128:129]
    v_pk_mul_f32 v[42:43], v[130:131], v[130:131]
    v_pk_mul_f32 v[44:45], v[132:133], v[132:133]
    v_pk_mul_f32 v[46:47], v[134:135], v[134:135]
    v_pk_fma_f32 v[40:41], v[40:41], v[10:11], v[8:9]
    v_pk_fma_f32 v[42:43], v[42:43], v[10:11], v[8:9]
    v_pk_fma_f32 v[44:45], v[44:45], v[10:11], v[8:9]
    v_pk_fma_f32 v[46:47], v[46:47], v[10:11], v[8:9]
    v_pk_mul_f32 v[40:41], v[40:41], v[128:129]
    v_pk_mul_f32 v[42:43], v[42:43], v[130:131]
    v_pk_mul_f32 v[44:45], v[44:45], v[132:133]
    v_pk_mul_f32 v[46:47], v[46:47], v[134:135]
    v_exp_f32 v40, v40
    v_exp_f32 v41, v41
    v_exp_f32 v42, v42
    v_exp_f32 v43, v43
    v_exp_f32 v44, v44
    v_exp_f32 v45, v45
    v_exp_f32 v46, v46
    v_exp_f32 v47, v47
    v_pk_add_f32 v[40:41], v[40:41], v[12:13]
    v_pk_add_f32 v[42:43], v[42:43], v[12:13]
    v_pk_add_f32 v[44:45], v[44:45], v[12:13]
    v_pk_add_f32 v[46:47], v[46:47], v[12:13]
    v_rcp_f32 v40, v40
    v_rcp_f32 v41, v41
    v_rcp_f32 v42, v42
    v_rcp_f32 v43, v43
    v_rcp_f32 v44, v44
    v_rcp_f32 v45, v45
    v_rcp_f32 v46, v46
    v_rcp_f32 v47, v47
    v_pk_mul_f32 v[128:129], v[40:41], v[128:129]
    v_pk_mul_f32 v[130:131], v[42:43], v[130:131]
    v_pk_mul_f32 v[132:133], v[44:45], v[132:133]
    v_pk_mul_f32 v[134:135], v[46:47], v[134:135]
    v_pk_mul_f32 v[32:33], v[136:137], v[136:137]
    v_pk_mul_f32 v[34:35], v[138:139], v[138:139]
    v_pk_mul_f32 v[36:37], v[140:141], v[140:141]
    v_pk_mul_f32 v[38:39], v[142:143], v[142:143]
    v_pk_fma_f32 v[32:33], v[32:33], v[10:11], v[8:9]
    v_pk_fma_f32 v[34:35], v[34:35], v[10:11], v[8:9]
    v_pk_fma_f32 v[36:37], v[36:37], v[10:11], v[8:9]
    v_pk_fma_f32 v[38:39], v[38:39], v[10:11], v[8:9]
    v_pk_mul_f32 v[32:33], v[32:33], v[136:137]
    v_pk_mul_f32 v[34:35], v[34:35], v[138:139]
    v_pk_mul_f32 v[36:37], v[36:37], v[140:141]
    v_pk_mul_f32 v[38:39], v[38:39], v[142:143]
    v_exp_f32 v32, v32
    v_exp_f32 v33, v33
    v_exp_f32 v34, v34
    v_exp_f32 v35, v35
    v_exp_f32 v36, v36
    v_exp_f32 v37, v37
    v_exp_f32 v38, v38
    v_exp_f32 v39, v39
    v_pk_add_f32 v[32:33], v[32:33], v[12:13]
    v_pk_add_f32 v[34:35], v[34:35], v[12:13]
    v_pk_add_f32 v[36:37], v[36:37], v[12:13]
    v_pk_add_f32 v[38:39], v[38:39], v[12:13]
    v_rcp_f32 v32, v32
    v_rcp_f32 v33, v33
    v_rcp_f32 v34, v34
    v_rcp_f32 v35, v35
    v_rcp_f32 v36, v36
    v_rcp_f32 v37, v37
    v_rcp_f32 v38, v38
    v_rcp_f32 v39, v39
    v_pk_mul_f32 v[136:137], v[32:33], v[136:137]
    v_pk_mul_f32 v[138:139], v[34:35], v[138:139]
    v_pk_mul_f32 v[140:141], v[36:37], v[140:141]
    v_pk_mul_f32 v[142:143], v[38:39], v[142:143]
    v_pk_mul_f32 v[40:41], v[144:145], v[144:145]
    v_pk_mul_f32 v[42:43], v[146:147], v[146:147]
    v_pk_mul_f32 v[44:45], v[148:149], v[148:149]
    v_pk_mul_f32 v[46:47], v[150:151], v[150:151]
    v_pk_fma_f32 v[40:41], v[40:41], v[10:11], v[8:9]
    v_pk_fma_f32 v[42:43], v[42:43], v[10:11], v[8:9]
    v_pk_fma_f32 v[44:45], v[44:45], v[10:11], v[8:9]
    v_pk_fma_f32 v[46:47], v[46:47], v[10:11], v[8:9]
    v_pk_mul_f32 v[40:41], v[40:41], v[144:145]
    v_pk_mul_f32 v[42:43], v[42:43], v[146:147]
    v_pk_mul_f32 v[44:45], v[44:45], v[148:149]
    v_pk_mul_f32 v[46:47], v[46:47], v[150:151]
    v_exp_f32 v40, v40
    v_exp_f32 v41, v41
    v_exp_f32 v42, v42
    v_exp_f32 v43, v43
    v_exp_f32 v44, v44
    v_exp_f32 v45, v45
    v_exp_f32 v46, v46
    v_exp_f32 v47, v47
    v_pk_add_f32 v[40:41], v[40:41], v[12:13]
    v_pk_add_f32 v[42:43], v[42:43], v[12:13]
    v_pk_add_f32 v[44:45], v[44:45], v[12:13]
    v_pk_add_f32 v[46:47], v[46:47], v[12:13]
    v_rcp_f32 v40, v40
    v_rcp_f32 v41, v41
    v_rcp_f32 v42, v42
    v_rcp_f32 v43, v43
    v_rcp_f32 v44, v44
    v_rcp_f32 v45, v45
    v_rcp_f32 v46, v46
    v_rcp_f32 v47, v47
    v_pk_mul_f32 v[144:145], v[40:41], v[144:145]
    v_pk_mul_f32 v[146:147], v[42:43], v[146:147]
    v_pk_mul_f32 v[148:149], v[44:45], v[148:149]
    v_pk_mul_f32 v[150:151], v[46:47], v[150:151]
    buffer_load_dwordx2 v[48:49], v14, s[36:39], s60 offen offset:0 sc1
    buffer_load_dwordx2 v[50:51], v14, s[36:39], s60 offen offset:512 sc1
    buffer_load_dwordx2 v[52:53], v14, s[36:39], s60 offen offset:1024 sc1
    buffer_load_dwordx2 v[54:55], v14, s[36:39], s60 offen offset:1536 sc1
    buffer_load_dwordx2 v[56:57], v14, s[36:39], s60 offen offset:2048 sc1
    buffer_load_dwordx2 v[58:59], v14, s[36:39], s60 offen offset:2560 sc1
    buffer_load_dwordx2 v[60:61], v14, s[36:39], s60 offen offset:3072 sc1
    buffer_load_dwordx2 v[62:63], v14, s[36:39], s60 offen offset:3584 sc1
    buffer_load_dwordx2 v[64:65], v14, s[36:39], s61 offen offset:0 sc1
    buffer_load_dwordx2 v[66:67], v14, s[36:39], s61 offen offset:512 sc1
    buffer_load_dwordx2 v[68:69], v14, s[36:39], s61 offen offset:1024 sc1
    buffer_load_dwordx2 v[70:71], v14, s[36:39], s61 offen offset:1536 sc1
    buffer_load_dwordx2 v[72:73], v14, s[36:39], s61 offen offset:2048 sc1
    buffer_load_dwordx2 v[74:75], v14, s[36:39], s61 offen offset:2560 sc1
    buffer_load_dwordx2 v[232:233], v14, s[36:39], s61 offen offset:3072 sc1
    buffer_load_dwordx2 v[234:235], v14, s[36:39], s61 offen offset:3584 sc1
    v_pk_mul_f32 v[32:33], v[216:217], v[216:217]
    v_pk_mul_f32 v[34:35], v[218:219], v[218:219]
    v_pk_mul_f32 v[36:37], v[220:221], v[220:221]
    v_pk_mul_f32 v[38:39], v[222:223], v[222:223]
    v_pk_fma_f32 v[32:33], v[32:33], v[10:11], v[8:9]
    v_pk_fma_f32 v[34:35], v[34:35], v[10:11], v[8:9]
    v_pk_fma_f32 v[36:37], v[36:37], v[10:11], v[8:9]
    v_pk_fma_f32 v[38:39], v[38:39], v[10:11], v[8:9]
    v_pk_mul_f32 v[32:33], v[32:33], v[216:217]
    v_pk_mul_f32 v[34:35], v[34:35], v[218:219]
    v_pk_mul_f32 v[36:37], v[36:37], v[220:221]
    v_pk_mul_f32 v[38:39], v[38:39], v[222:223]
    v_exp_f32 v32, v32
    v_exp_f32 v33, v33
    v_exp_f32 v34, v34
    v_exp_f32 v35, v35
    v_exp_f32 v36, v36
    v_exp_f32 v37, v37
    v_exp_f32 v38, v38
    v_exp_f32 v39, v39
    v_pk_add_f32 v[32:33], v[32:33], v[12:13]
    v_pk_add_f32 v[34:35], v[34:35], v[12:13]
    v_pk_add_f32 v[36:37], v[36:37], v[12:13]
    v_pk_add_f32 v[38:39], v[38:39], v[12:13]
    v_rcp_f32 v32, v32
    v_rcp_f32 v33, v33
    v_rcp_f32 v34, v34
    v_rcp_f32 v35, v35
    v_rcp_f32 v36, v36
    v_rcp_f32 v37, v37
    v_rcp_f32 v38, v38
    v_rcp_f32 v39, v39
    v_pk_mul_f32 v[216:217], v[32:33], v[216:217]
    v_pk_mul_f32 v[218:219], v[34:35], v[218:219]
    v_pk_mul_f32 v[220:221], v[36:37], v[220:221]
    v_pk_mul_f32 v[222:223], v[38:39], v[222:223]
    s_waitcnt lgkmcnt(0)
    s_mov_b32 s28, s20
    s_mov_b32 s29, s21
    s_mov_b32 s30, 41218048
    s_mov_b32 s31, 0x00020000
    s_mov_b32 s32, s10
    s_mov_b32 s33, s11
    s_mov_b32 s34, 4096
    s_mov_b32 s35, 0x00020000
    s_mov_b32 s24, s8
    s_mov_b32 s25, s9
    s_mov_b32 s26, 8388608
    s_mov_b32 s27, 0x00020000
    v_lshrrev_b32 v5, 3, v0
    v_and_b32 v2, 7, v0
    v_lshrrev_b32 v6, 1, v5
    v_xor_b32 v2, v2, v6
    v_lshrrev_b32 v6, 2, v5
    v_and_b32 v5, 3, v5
    v_lshl_add_u32 v5, v6, 3, v5
    s_lshl_b32 s15, s3, 5
    v_add_u32 v5, s15, v5
    v_lshlrev_b32 v5, 12, v5
    v_lshl_add_u32 v76, v2, 4, v5
    v_xor_b32 v77, 64, v76
    v_add_u32 v78, 14336, v76
    v_add_u32 v79, 78848, v77
    v_add_u32 v77, 64512, v77
    s_lshl_b32 s64, s47, 12
    s_and_b32 s52, s45, 12
    s_add_u32 s46, s44, s52
    s_add_u32 s46, s46, 1
    s_and_b32 s46, s46, 15
    s_lshl_b32 s54, s46, 8
    s_mul_i32 s66, s46, 1179648
    s_bitcmp1_b32 s45, 0
    s_cbranch_scc1 GF_PK1
    v_cvt_pk_bf16_f32 v88, v88, v89
    v_cvt_pk_bf16_f32 v89, v90, v91
    v_cvt_pk_bf16_f32 v90, v92, v93
    v_cvt_pk_bf16_f32 v91, v94, v95
    v_cvt_pk_bf16_f32 v92, v96, v97
    v_cvt_pk_bf16_f32 v93, v98, v99
    v_cvt_pk_bf16_f32 v94, v100, v101
    v_cvt_pk_bf16_f32 v95, v102, v103
    v_cvt_pk_bf16_f32 v96, v104, v105
    v_cvt_pk_bf16_f32 v97, v106, v107
    v_cvt_pk_bf16_f32 v98, v108, v109
    v_cvt_pk_bf16_f32 v99, v110, v111
    v_cvt_pk_bf16_f32 v100, v112, v113
    v_cvt_pk_bf16_f32 v101, v114, v115
    v_cvt_pk_bf16_f32 v102, v116, v117
    v_cvt_pk_bf16_f32 v103, v118, v119
    v_cvt_pk_bf16_f32 v104, v120, v121
    v_cvt_pk_bf16_f32 v105, v122, v123
    v_cvt_pk_bf16_f32 v106, v124, v125
    v_cvt_pk_bf16_f32 v107, v126, v127
    v_cvt_pk_bf16_f32 v108, v128, v129
    v_cvt_pk_bf16_f32 v109, v130, v131
    v_cvt_pk_bf16_f32 v110, v132, v133
    v_cvt_pk_bf16_f32 v111, v134, v135
    v_cvt_pk_bf16_f32 v112, v136, v137
    v_cvt_pk_bf16_f32 v113, v138, v139
    v_cvt_pk_bf16_f32 v114, v140, v141
    v_cvt_pk_bf16_f32 v115, v142, v143
    v_cvt_pk_bf16_f32 v116, v144, v145
    v_cvt_pk_bf16_f32 v117, v146, v147
    v_cvt_pk_bf16_f32 v118, v148, v149
    v_cvt_pk_bf16_f32 v119, v150, v151
    v_cvt_pk_bf16_f32 v120, v216, v217
    v_cvt_pk_bf16_f32 v121, v218, v219
    v_cvt_pk_bf16_f32 v122, v220, v221
    v_cvt_pk_bf16_f32 v123, v222, v223
    s_branch GF_PKD
GF_PK1:
    v_cvt_pk_bf16_f32 v95, v94, v95
    v_cvt_pk_bf16_f32 v94, v92, v93
    v_cvt_pk_bf16_f32 v93, v90, v91
    v_cvt_pk_bf16_f32 v92, v88, v89
    v_cvt_pk_bf16_f32 v96, v96, v97
    v_cvt_pk_bf16_f32 v97, v98, v99
    v_cvt_pk_bf16_f32 v98, v100, v101
    v_cvt_pk_bf16_f32 v99, v102, v103
    v_cvt_pk_bf16_f32 v100, v104, v105
    v_cvt_pk_bf16_f32 v101, v106, v107
    v_cvt_pk_bf16_f32 v102, v108, v109
    v_cvt_pk_bf16_f32 v103, v110, v111
    v_cvt_pk_bf16_f32 v104, v112, v113
    v_cvt_pk_bf16_f32 v105, v114, v115
    v_cvt_pk_bf16_f32 v106, v116, v117
    v_cvt_pk_bf16_f32 v107, v118, v119
    v_cvt_pk_bf16_f32 v108, v120, v121
    v_cvt_pk_bf16_f32 v109, v122, v123
    v_cvt_pk_bf16_f32 v110, v124, v125
    v_cvt_pk_bf16_f32 v111, v126, v127
    v_cvt_pk_bf16_f32 v112, v128, v129
    v_cvt_pk_bf16_f32 v113, v130, v131
    v_cvt_pk_bf16_f32 v114, v132, v133
    v_cvt_pk_bf16_f32 v115, v134, v135
    v_cvt_pk_bf16_f32 v116, v136, v137
    v_cvt_pk_bf16_f32 v117, v138, v139
    v_cvt_pk_bf16_f32 v118, v140, v141
    v_cvt_pk_bf16_f32 v119, v142, v143
    v_cvt_pk_bf16_f32 v120, v144, v145
    v_cvt_pk_bf16_f32 v121, v146, v147
    v_cvt_pk_bf16_f32 v122, v148, v149
    v_cvt_pk_bf16_f32 v123, v150, v151
    v_cvt_pk_bf16_f32 v88, v216, v217
    v_cvt_pk_bf16_f32 v89, v218, v219
    v_cvt_pk_bf16_f32 v90, v220, v221
    v_cvt_pk_bf16_f32 v91, v222, v223
GF_PKD:
    v_mov_b32 v132, v15
    v_mov_b32 v124, v1
    s_lshl_b32 s4, s45, 8
    s_add_u32 s4, s4, 41172992
    s_mov_b32 s53, s4
    s_mul_i32 s15, s45, 9
    s_add_u32 s15, s15, 144
    s_lshl_b32 s15, s15, 10
    s_add_u32 s15, s15, 5505024
    s_add_u32 s15, s15, s66
    s_mov_b32 s66, 1179648
    s_mul_i32 s22, s47, 6144
    s_add_u32 s22, s22, s15
    s_add_u32 s23, s22, 3072
    s_add_u32 s42, s15, 294912
    s_cmp_eq_u32 s47, 1
    s_cselect_b32 s23, s42, s23
    s_add_u32 s6, s42, 3072
    s_add_u32 s7, s42, 6144
    s_cmp_eq_u32 s47, 2
    s_cselect_b32 s22, s6, s22
    s_cselect_b32 s23, s7, s23
    s_mov_b32 s42, 589824
    s_mov_b32 s41, 3072
    s_cmp_eq_u32 s47, 3
    s_cselect_b32 s22, 4746240, s22
    s_cselect_b32 s23, 4748288, s23
    s_cselect_b32 s41, 2048, s41
    s_cselect_b32 s42, 4608, s42
    s_cselect_b32 s66, 0, s66
    s_mul_i32 s43, s47, 6144
    s_add_u32 s43, s43, 16384
    s_add_u32 s40, s43, s41
    v_lshlrev_b32 v133, 2, v0
    s_mov_b32 s14, 2654208
    s_mov_b32 s15, 0x00020000
    s_mov_b32 s18, 663552
    s_mov_b32 s19, 0x00020000
    v_lshlrev_b32 v136, 4, v4
    v_lshlrev_b32 v137, 6, v4
    v_lshlrev_b32 v138, 7, v0
    s_lshl_b32 s65, s3, 8
    s_add_u32 s65, s65, 41193472
    v_and_b32 v2, 15, v0
    v_bfe_u32 v32, v0, 1, 3
    v_xor_b32 v32, v32, v4
    v_lshlrev_b32 v32, 4, v32
    v_lshl_add_u32 v32, v2, 7, v32
    v_add_u32 v126, s64, v32
    v_xor_b32 v127, 64, v126
    v_add_u32 v128, 81920, v126
    v_add_u32 v129, 81920, v127
    v_add_u32 v130, 16384, v124
    v_add_u32 v131, 98304, v124
    v_and_b32 v2, 3, v0
    v_lshlrev_b32 v2, 8, v2
    v_bfe_u32 v32, v0, 2, 1
    v_mul_u32_u24 v32, 40960, v32
    v_add_u32 v2, v2, v32
    v_and_b32 v32, 7, v0
    v_lshl_add_u32 v2, v32, 2, v2
    v_add_u32 v82, 39936, v2
    v_lshrrev_b32 v134, 2, v0
    v_subrev_u32 v134, s44, v134
    v_and_b32 v134, 15, v134
    v_cmp_eq_u32 s[50:51], 0, v134
    v_subrev_u32 v134, s52, v134
    v_add_u32 v32, 15, v134
    v_cmp_lt_i32 vcc, 0, v134
    s_nop 1
    v_cndmask_b32 v134, v32, v134, vcc
    v_cndmask_b32 v134, v134, 63, s[50:51]
GF_CHK:
    s_mov_b32 s58, 0
    s_waitcnt vmcnt(0)
    v_cmp_ne_u32 vcc, v15, v49
    s_nop 1
    s_cbranch_vccz GF_CK0
    buffer_load_dwordx2 v[48:49], v14, s[36:39], s60 offen offset:0 sc1
    s_mov_b32 s58, 1
GF_CK0:
    v_cmp_ne_u32 vcc, v15, v51
    s_nop 1
    s_cbranch_vccz GF_CK1
    buffer_load_dwordx2 v[50:51], v14, s[36:39], s60 offen offset:512 sc1
    s_mov_b32 s58, 1
GF_CK1:
    v_cmp_ne_u32 vcc, v15, v53
    s_nop 1
    s_cbranch_vccz GF_CK2
    buffer_load_dwordx2 v[52:53], v14, s[36:39], s60 offen offset:1024 sc1
    s_mov_b32 s58, 1
GF_CK2:
    v_cmp_ne_u32 vcc, v15, v55
    s_nop 1
    s_cbranch_vccz GF_CK3
    buffer_load_dwordx2 v[54:55], v14, s[36:39], s60 offen offset:1536 sc1
    s_mov_b32 s58, 1
GF_CK3:
    v_cmp_ne_u32 vcc, v15, v57
    s_nop 1
    s_cbranch_vccz GF_CK4
    buffer_load_dwordx2 v[56:57], v14, s[36:39], s60 offen offset:2048 sc1
    s_mov_b32 s58, 1
GF_CK4:
    v_cmp_ne_u32 vcc, v15, v59
    s_nop 1
    s_cbranch_vccz GF_CK5
    buffer_load_dwordx2 v[58:59], v14, s[36:39], s60 offen offset:2560 sc1
    s_mov_b32 s58, 1
GF_CK5:
    v_cmp_ne_u32 vcc, v15, v61
    s_nop 1
    s_cbranch_vccz GF_CK6
    buffer_load_dwordx2 v[60:61], v14, s[36:39], s60 offen offset:3072 sc1
    s_mov_b32 s58, 1
GF_CK6:
    v_cmp_ne_u32 vcc, v15, v63
    s_nop 1
    s_cbranch_vccz GF_CK7
    buffer_load_dwordx2 v[62:63], v14, s[36:39], s60 offen offset:3584 sc1
    s_mov_b32 s58, 1
GF_CK7:
    v_cmp_ne_u32 vcc, v15, v65
    s_nop 1
    s_cbranch_vccz GF_CK8
    buffer_load_dwordx2 v[64:65], v14, s[36:39], s61 offen offset:0 sc1
    s_mov_b32 s58, 1
GF_CK8:
    v_cmp_ne_u32 vcc, v15, v67
    s_nop 1
    s_cbranch_vccz GF_CK9
    buffer_load_dwordx2 v[66:67], v14, s[36:39], s61 offen offset:512 sc1
    s_mov_b32 s58, 1
GF_CK9:
    v_cmp_ne_u32 vcc, v15, v69
    s_nop 1
    s_cbranch_vccz GF_CK10
    buffer_load_dwordx2 v[68:69], v14, s[36:39], s61 offen offset:1024 sc1
    s_mov_b32 s58, 1
GF_CK10:
    v_cmp_ne_u32 vcc, v15, v71
    s_nop 1
    s_cbranch_vccz GF_CK11
    buffer_load_dwordx2 v[70:71], v14, s[36:39], s61 offen offset:1536 sc1
    s_mov_b32 s58, 1
GF_CK11:
    v_cmp_ne_u32 vcc, v15, v73
    s_nop 1
    s_cbranch_vccz GF_CK12
    buffer_load_dwordx2 v[72:73], v14, s[36:39], s61 offen offset:2048 sc1
    s_mov_b32 s58, 1
GF_CK12:
    v_cmp_ne_u32 vcc, v15, v75
    s_nop 1
    s_cbranch_vccz GF_CK13
    buffer_load_dwordx2 v[74:75], v14, s[36:39], s61 offen offset:2560 sc1
    s_mov_b32 s58, 1
GF_CK13:
    v_cmp_ne_u32 vcc, v15, v233
    s_nop 1
    s_cbranch_vccz GF_CK14
    buffer_load_dwordx2 v[232:233], v14, s[36:39], s61 offen offset:3072 sc1
    s_mov_b32 s58, 1
GF_CK14:
    v_cmp_ne_u32 vcc, v15, v235
    s_nop 1
    s_cbranch_vccz GF_CK15
    buffer_load_dwordx2 v[234:235], v14, s[36:39], s61 offen offset:3584 sc1
    s_mov_b32 s58, 1
GF_CK15:
    s_add_u32 s62, s62, 1
    s_cmp_lt_u32 s62, 0x20000
    s_cselect_b32 s58, s58, 0
    s_cmp_lg_u32 s58, 0
    s_cbranch_scc1 GF_CHK
    s_waitcnt vmcnt(0)
    v_add_f32 v32, v48, v50
    v_add_f32 v33, v52, v54
    v_add_f32 v32, v32, v56
    v_add_f32 v33, v33, v58
    v_add_f32 v32, v32, v60
    v_add_f32 v33, v33, v62
    v_add_f32 v32, v32, v64
    v_add_f32 v33, v33, v66
    v_add_f32 v32, v32, v68
    v_add_f32 v33, v33, v70
    v_add_f32 v32, v32, v72
    v_add_f32 v33, v33, v74
    v_add_f32 v32, v32, v232
    v_add_f32 v33, v33, v234
    v_add_f32 v32, v32, v33
GF_GO:
    v_mul_f32 v32, 0x39e38e39, v32
    s_nop 1
    v_mov_b32_dpp v33, v32 row_ror:8 row_mask:0xf bank_mask:0xf
    v_fma_f32 v33, -v32, v32, v33
    v_max_f32 v33, 0, v33
    v_cvt_pk_bf16_f32 v32, v32, v32
    v_and_b32 v32, 0xffff0000, v32
    v_cvt_pk_bf16_f32 v33, v33, v33
    v_and_b32 v33, 0xffff0000, v33
    v_add_f32 v33, 0x3727c5ac, v33
    v_cvt_pk_bf16_f32 v33, v33, v33
    v_and_b32 v33, 0xffff0000, v33
    v_sqrt_f32 v33, v33
    s_nop 0
    v_cvt_pk_bf16_f32 v33, v33, v33
    v_and_b32 v33, 0xffff0000, v33
    v_rcp_f32 v33, v33
    s_nop 0
    v_mul_f32 v32, -v32, v33
    s_and_b32 s49, s45, 1
    s_mul_i32 s4, s3, 288
    s_mul_i32 s5, s45, 9
    s_add_u32 s4, s4, s5
    s_lshl_b32 s4, s4, 10
    s_add_u32 s4, s4, 5652480
    s_lshl_b32 s5, s49, 10
    s_add_u32 s55, s4, s5
    s_add_u32 s56, s55, 4096
    s_lshr_b32 s6, s47, 1
    s_mul_i32 s6, s6, 40960
    s_and_b32 s7, s47, 1
    s_mul_i32 s7, s7, 9216
    s_add_u32 s6, s6, s7
    s_add_u32 s6, s6, 16384
    s_add_u32 s7, s6, s5
    v_add_u32 v5, s7, v1
    s_cmp_eq_u32 s49, 0
    s_cselect_b32 s5, 8192, 0
    s_add_u32 s57, s4, s5
    s_add_u32 s7, s6, s5
    v_add_u32 v6, s7, v1
    v_mov_b32_dpp v16, v33 row_newbcast:0 row_mask:0xf bank_mask:0xf
    v_mov_b32_dpp v24, v32 row_newbcast:0 row_mask:0xf bank_mask:0xf
    v_mov_b32_dpp v17, v33 row_newbcast:1 row_mask:0xf bank_mask:0xf
    v_mov_b32_dpp v25, v32 row_newbcast:1 row_mask:0xf bank_mask:0xf
    v_mov_b32_dpp v18, v33 row_newbcast:2 row_mask:0xf bank_mask:0xf
    v_mov_b32_dpp v26, v32 row_newbcast:2 row_mask:0xf bank_mask:0xf
    v_mov_b32_dpp v19, v33 row_newbcast:3 row_mask:0xf bank_mask:0xf
    v_mov_b32_dpp v27, v32 row_newbcast:3 row_mask:0xf bank_mask:0xf
    v_mov_b32_dpp v20, v33 row_newbcast:4 row_mask:0xf bank_mask:0xf
    v_mov_b32_dpp v28, v32 row_newbcast:4 row_mask:0xf bank_mask:0xf
    v_mov_b32_dpp v21, v33 row_newbcast:5 row_mask:0xf bank_mask:0xf
    v_mov_b32_dpp v29, v32 row_newbcast:5 row_mask:0xf bank_mask:0xf
    v_mov_b32_dpp v22, v33 row_newbcast:6 row_mask:0xf bank_mask:0xf
    v_mov_b32_dpp v30, v32 row_newbcast:6 row_mask:0xf bank_mask:0xf
    v_mov_b32_dpp v23, v33 row_newbcast:7 row_mask:0xf bank_mask:0xf
    v_mov_b32_dpp v31, v32 row_newbcast:7 row_mask:0xf bank_mask:0xf
    v_pk_fma_f32 v[152:153], v[152:153], v[16:17], v[24:25]
    v_pk_fma_f32 v[154:155], v[154:155], v[18:19], v[26:27]
    v_pk_fma_f32 v[156:157], v[156:157], v[20:21], v[28:29]
    v_pk_fma_f32 v[158:159], v[158:159], v[22:23], v[30:31]
    v_cvt_pk_bf16_f32 v152, v152, v153
    v_cvt_pk_bf16_f32 v153, v154, v155
    v_cvt_pk_bf16_f32 v154, v156, v157
    v_cvt_pk_bf16_f32 v155, v158, v159
    buffer_store_dwordx4 v[152:155], v1, s[36:39], s55 offen offset:0 sc1
    ds_write_b128 v5, v[152:155] offset:0
    v_pk_fma_f32 v[160:161], v[160:161], v[16:17], v[24:25]
    v_pk_fma_f32 v[162:163], v[162:163], v[18:19], v[26:27]
    v_pk_fma_f32 v[164:165], v[164:165], v[20:21], v[28:29]
    v_pk_fma_f32 v[166:167], v[166:167], v[22:23], v[30:31]
    v_cvt_pk_bf16_f32 v160, v160, v161
    v_cvt_pk_bf16_f32 v161, v162, v163
    v_cvt_pk_bf16_f32 v162, v164, v165
    v_cvt_pk_bf16_f32 v163, v166, v167
    buffer_store_dwordx4 v[160:163], v1, s[36:39], s55 offen offset:1024 sc1
    ds_write_b128 v5, v[160:163] offset:1024
    v_pk_fma_f32 v[168:169], v[168:169], v[16:17], v[24:25]
    v_pk_fma_f32 v[170:171], v[170:171], v[18:19], v[26:27]
    v_pk_fma_f32 v[172:173], v[172:173], v[20:21], v[28:29]
    v_pk_fma_f32 v[174:175], v[174:175], v[22:23], v[30:31]
    v_cvt_pk_bf16_f32 v168, v168, v169
    v_cvt_pk_bf16_f32 v169, v170, v171
    v_cvt_pk_bf16_f32 v170, v172, v173
    v_cvt_pk_bf16_f32 v171, v174, v175
    buffer_store_dwordx4 v[168:171], v1, s[36:39], s55 offen offset:2048 sc1
    ds_write_b128 v5, v[168:171] offset:2048
    v_pk_fma_f32 v[176:177], v[176:177], v[16:17], v[24:25]
    v_pk_fma_f32 v[178:179], v[178:179], v[18:19], v[26:27]
    v_pk_fma_f32 v[180:181], v[180:181], v[20:21], v[28:29]
    v_pk_fma_f32 v[182:183], v[182:183], v[22:23], v[30:31]
    v_cvt_pk_bf16_f32 v176, v176, v177
    v_cvt_pk_bf16_f32 v177, v178, v179
    v_cvt_pk_bf16_f32 v178, v180, v181
    v_cvt_pk_bf16_f32 v179, v182, v183
    buffer_store_dwordx4 v[176:179], v1, s[36:39], s55 offen offset:3072 sc1
    ds_write_b128 v5, v[176:179] offset:3072
    v_pk_fma_f32 v[184:185], v[184:185], v[16:17], v[24:25]
    v_pk_fma_f32 v[186:187], v[186:187], v[18:19], v[26:27]
    v_pk_fma_f32 v[188:189], v[188:189], v[20:21], v[28:29]
    v_pk_fma_f32 v[190:191], v[190:191], v[22:23], v[30:31]
    v_cvt_pk_bf16_f32 v184, v184, v185
    v_cvt_pk_bf16_f32 v185, v186, v187
    v_cvt_pk_bf16_f32 v186, v188, v189
    v_cvt_pk_bf16_f32 v187, v190, v191
    buffer_store_dwordx4 v[184:187], v1, s[36:39], s56 offen offset:0 sc1
    ds_write_b128 v5, v[184:187] offset:4096
    v_pk_fma_f32 v[192:193], v[192:193], v[16:17], v[24:25]
    v_pk_fma_f32 v[194:195], v[194:195], v[18:19], v[26:27]
    v_pk_fma_f32 v[196:197], v[196:197], v[20:21], v[28:29]
    v_pk_fma_f32 v[198:199], v[198:199], v[22:23], v[30:31]
    v_cvt_pk_bf16_f32 v192, v192, v193
    v_cvt_pk_bf16_f32 v193, v194, v195
    v_cvt_pk_bf16_f32 v194, v196, v197
    v_cvt_pk_bf16_f32 v195, v198, v199
    buffer_store_dwordx4 v[192:195], v1, s[36:39], s56 offen offset:1024 sc1
    ds_write_b128 v5, v[192:195] offset:5120
    v_pk_fma_f32 v[200:201], v[200:201], v[16:17], v[24:25]
    v_pk_fma_f32 v[202:203], v[202:203], v[18:19], v[26:27]
    v_pk_fma_f32 v[204:205], v[204:205], v[20:21], v[28:29]
    v_pk_fma_f32 v[206:207], v[206:207], v[22:23], v[30:31]
    v_cvt_pk_bf16_f32 v200, v200, v201
    v_cvt_pk_bf16_f32 v201, v202, v203
    v_cvt_pk_bf16_f32 v202, v204, v205
    v_cvt_pk_bf16_f32 v203, v206, v207
    buffer_store_dwordx4 v[200:203], v1, s[36:39], s56 offen offset:2048 sc1
    ds_write_b128 v5, v[200:203] offset:6144
    v_pk_fma_f32 v[208:209], v[208:209], v[16:17], v[24:25]
    v_pk_fma_f32 v[210:211], v[210:211], v[18:19], v[26:27]
    v_pk_fma_f32 v[212:213], v[212:213], v[20:21], v[28:29]
    v_pk_fma_f32 v[214:215], v[214:215], v[22:23], v[30:31]
    v_cvt_pk_bf16_f32 v208, v208, v209
    v_cvt_pk_bf16_f32 v209, v210, v211
    v_cvt_pk_bf16_f32 v210, v212, v213
    v_cvt_pk_bf16_f32 v211, v214, v215
    buffer_store_dwordx4 v[208:211], v1, s[36:39], s56 offen offset:3072 sc1
    ds_write_b128 v5, v[208:211] offset:7168
    v_pk_fma_f32 v[224:225], v[224:225], v[16:17], v[24:25]
    v_pk_fma_f32 v[226:227], v[226:227], v[18:19], v[26:27]
    v_pk_fma_f32 v[228:229], v[228:229], v[20:21], v[28:29]
    v_pk_fma_f32 v[230:231], v[230:231], v[22:23], v[30:31]
    v_cvt_pk_bf16_f32 v224, v224, v225
    v_cvt_pk_bf16_f32 v225, v226, v227
    v_cvt_pk_bf16_f32 v226, v228, v229
    v_cvt_pk_bf16_f32 v227, v230, v231
    buffer_store_dwordx4 v[224:227], v1, s[36:39], s57 offen offset:0 sc1
    ds_write_b128 v6, v[224:227] offset:0
    s_mov_b32 s56, s22
    s_mov_b32 s57, s23
    s_mov_b32 s58, s42
    s_mov_b32 s59, s64
    s_mov_b32 s60, s43
    s_mov_b32 s61, s40
    s_mov_b32 s4, s53
    s_lshl_b32 s64, s3, 2
    s_add_u32 s64, s64, s4
    s_lshl_b32 s7, s3, 6
    s_cmp_eq_u32 s47, 3
    s_cselect_b32 s48, 1, 0
    v_mov_b32 v32, 162880
    s_waitcnt lgkmcnt(0)
    s_mov_b64 exec, 1
    ds_add_u32 v32, v85
    s_mov_b64 exec, -1
GF_GW0:
    ds_read_b32 v33, v32
    s_waitcnt lgkmcnt(0)
    v_cmp_gt_u32 vcc, 8, v33
    s_nop 1
    s_cbranch_vccnz GF_GW0
    s_setprio 0
    ds_read_b128 v[8:11], v126 offset:0
    ds_read_b128 v[12:15], v126 offset:2048
    ds_read_b128 v[24:27], v130 offset:0
    ds_read_b128 v[28:31], v130 offset:1024
    ds_read_b128 v[32:35], v130 offset:2048
    ds_read_b128 v[36:39], v130 offset:3072
    ds_read_b128 v[40:43], v130 offset:4096
    ds_read_b128 v[44:47], v130 offset:5120
    ds_read_b128 v[48:51], v130 offset:6144
    s_waitcnt lgkmcnt(6)
    v_mfma_f32_16x16x32_bf16 v[184:187], v[8:11], v[24:27], 0
    ds_read_b128 v[52:55], v130 offset:7168
    v_mfma_f32_16x16x32_bf16 v[188:191], v[12:15], v[24:27], 0
    s_waitcnt lgkmcnt(6)
    v_mfma_f32_16x16x32_bf16 v[192:195], v[8:11], v[28:31], 0
    ds_read_b128 v[56:59], v130 offset:8192
    v_mfma_f32_16x16x32_bf16 v[196:199], v[12:15], v[28:31], 0
    ds_read_b128 v[16:19], v127 offset:0
    ds_read_b128 v[20:23], v127 offset:2048
    s_waitcnt lgkmcnt(8)
    v_mfma_f32_16x16x32_bf16 v[200:203], v[8:11], v[32:35], 0
    ds_read_b128 v[24:27], v130 offset:9216
    v_mfma_f32_16x16x32_bf16 v[204:207], v[12:15], v[32:35], 0
    s_waitcnt lgkmcnt(8)
    v_mfma_f32_16x16x32_bf16 v[208:211], v[8:11], v[36:39], 0
    ds_read_b128 v[28:31], v130 offset:10240
    v_mfma_f32_16x16x32_bf16 v[212:215], v[12:15], v[36:39], 0
    s_waitcnt lgkmcnt(8)
    v_mfma_f32_16x16x32_bf16 v[216:219], v[8:11], v[40:43], 0
    ds_read_b128 v[32:35], v130 offset:11264
    v_mfma_f32_16x16x32_bf16 v[220:223], v[12:15], v[40:43], 0
    s_waitcnt lgkmcnt(8)
    v_mfma_f32_16x16x32_bf16 v[224:227], v[8:11], v[44:47], 0
    ds_read_b128 v[36:39], v130 offset:12288
    v_mfma_f32_16x16x32_bf16 v[228:231], v[12:15], v[44:47], 0
    s_waitcnt lgkmcnt(8)
    v_mfma_f32_16x16x32_bf16 v[232:235], v[8:11], v[48:51], 0
    ds_read_b128 v[40:43], v130 offset:13312
    v_mfma_f32_16x16x32_bf16 v[236:239], v[12:15], v[48:51], 0
    s_waitcnt lgkmcnt(8)
    v_mfma_f32_16x16x32_bf16 v[240:243], v[8:11], v[52:55], 0
    ds_read_b128 v[44:47], v130 offset:14336
    v_mfma_f32_16x16x32_bf16 v[244:247], v[12:15], v[52:55], 0
    s_waitcnt lgkmcnt(8)
    v_mfma_f32_16x16x32_bf16 v[248:251], v[8:11], v[56:59], 0
    ds_read_b128 v[48:51], v130 offset:15360
    v_mfma_f32_16x16x32_bf16 v[252:255], v[12:15], v[56:59], 0
    s_waitcnt lgkmcnt(6)
    v_mfma_f32_16x16x32_bf16 v[184:187], v[16:19], v[24:27], v[184:187]
    ds_read_b128 v[52:55], v130 offset:16384
    v_mfma_f32_16x16x32_bf16 v[188:191], v[20:23], v[24:27], v[188:191]
    s_waitcnt vmcnt(0)
    s_mov_b64 exec, 1
    buffer_store_dword v132, v3, s[36:39], s64 offen sc1
    s_mov_b64 exec, -1
    s_add_u32 m0, s59, 81920
    s_nop 0
    buffer_load_dwordx4 v76, s[24:27], s54 offen offset:0 lds
    buffer_load_dwordx4 v77, s[24:27], s54 offen offset:1024 lds
    buffer_load_dwordx4 v78, s[24:27], s54 offen offset:2048 lds
    buffer_load_dwordx4 v79, s[24:27], s54 offen offset:3072 lds
    s_waitcnt lgkmcnt(6)
    v_mfma_f32_16x16x32_bf16 v[192:195], v[16:19], v[28:31], v[192:195]
    ds_read_b128 v[56:59], v130 offset:17408
    v_mfma_f32_16x16x32_bf16 v[196:199], v[20:23], v[28:31], v[196:199]
    ds_read_b128 v[8:11], v126 offset:40960
    ds_read_b128 v[12:15], v126 offset:43008
    s_waitcnt lgkmcnt(8)
    v_mfma_f32_16x16x32_bf16 v[200:203], v[16:19], v[32:35], v[200:203]
    ds_read_b128 v[24:27], v130 offset:40960
    v_mfma_f32_16x16x32_bf16 v[204:207], v[20:23], v[32:35], v[204:207]
    s_waitcnt lgkmcnt(8)
    v_mfma_f32_16x16x32_bf16 v[208:211], v[16:19], v[36:39], v[208:211]
    ds_read_b128 v[28:31], v130 offset:41984
    v_mfma_f32_16x16x32_bf16 v[212:215], v[20:23], v[36:39], v[212:215]
    s_waitcnt lgkmcnt(8)
    v_mfma_f32_16x16x32_bf16 v[216:219], v[16:19], v[40:43], v[216:219]
    ds_read_b128 v[32:35], v130 offset:43008
    v_mfma_f32_16x16x32_bf16 v[220:223], v[20:23], v[40:43], v[220:223]
    s_waitcnt lgkmcnt(8)
    v_mfma_f32_16x16x32_bf16 v[224:227], v[16:19], v[44:47], v[224:227]
    ds_read_b128 v[36:39], v130 offset:44032
    v_mfma_f32_16x16x32_bf16 v[228:231], v[20:23], v[44:47], v[228:231]
    s_waitcnt lgkmcnt(8)
    v_mfma_f32_16x16x32_bf16 v[232:235], v[16:19], v[48:51], v[232:235]
    ds_read_b128 v[40:43], v130 offset:45056
    v_mfma_f32_16x16x32_bf16 v[236:239], v[20:23], v[48:51], v[236:239]
    s_waitcnt lgkmcnt(8)
    v_mfma_f32_16x16x32_bf16 v[240:243], v[16:19], v[52:55], v[240:243]
    ds_read_b128 v[44:47], v130 offset:46080
    v_mfma_f32_16x16x32_bf16 v[244:247], v[20:23], v[52:55], v[244:247]
    s_waitcnt lgkmcnt(8)
    v_mfma_f32_16x16x32_bf16 v[248:251], v[16:19], v[56:59], v[248:251]
    ds_read_b128 v[48:51], v130 offset:47104
    v_mfma_f32_16x16x32_bf16 v[252:255], v[20:23], v[56:59], v[252:255]
    s_waitcnt lgkmcnt(6)
    v_mfma_f32_16x16x32_bf16 v[184:187], v[8:11], v[24:27], v[184:187]
    ds_read_b128 v[52:55], v130 offset:48128
    v_mfma_f32_16x16x32_bf16 v[188:191], v[12:15], v[24:27], v[188:191]
    s_waitcnt lgkmcnt(6)
    v_mfma_f32_16x16x32_bf16 v[192:195], v[8:11], v[28:31], v[192:195]
    ds_read_b128 v[56:59], v130 offset:49152
    v_mfma_f32_16x16x32_bf16 v[196:199], v[12:15], v[28:31], v[196:199]
    ds_read_b128 v[16:19], v127 offset:40960
    ds_read_b128 v[20:23], v127 offset:43008
    s_waitcnt lgkmcnt(8)
    v_mfma_f32_16x16x32_bf16 v[200:203], v[8:11], v[32:35], v[200:203]
    ds_read_b128 v[24:27], v130 offset:50176
    v_mfma_f32_16x16x32_bf16 v[204:207], v[12:15], v[32:35], v[204:207]
    s_waitcnt lgkmcnt(8)
    v_mfma_f32_16x16x32_bf16 v[208:211], v[8:11], v[36:39], v[208:211]
    ds_read_b128 v[28:31], v130 offset:51200
    v_mfma_f32_16x16x32_bf16 v[212:215], v[12:15], v[36:39], v[212:215]
    s_waitcnt lgkmcnt(8)
    v_mfma_f32_16x16x32_bf16 v[216:219], v[8:11], v[40:43], v[216:219]
    ds_read_b128 v[32:35], v130 offset:52224
    v_mfma_f32_16x16x32_bf16 v[220:223], v[12:15], v[40:43], v[220:223]
    s_waitcnt lgkmcnt(8)
    v_mfma_f32_16x16x32_bf16 v[224:227], v[8:11], v[44:47], v[224:227]
    ds_read_b128 v[36:39], v130 offset:53248
    v_mfma_f32_16x16x32_bf16 v[228:231], v[12:15], v[44:47], v[228:231]
    s_waitcnt lgkmcnt(8)
    v_mfma_f32_16x16x32_bf16 v[232:235], v[8:11], v[48:51], v[232:235]
    ds_read_b128 v[40:43], v130 offset:54272
    v_mfma_f32_16x16x32_bf16 v[236:239], v[12:15], v[48:51], v[236:239]
    s_waitcnt lgkmcnt(8)
    v_mfma_f32_16x16x32_bf16 v[240:243], v[8:11], v[52:55], v[240:243]
    ds_read_b128 v[44:47], v130 offset:55296
    v_mfma_f32_16x16x32_bf16 v[244:247], v[12:15], v[52:55], v[244:247]
    s_waitcnt lgkmcnt(8)
    v_mfma_f32_16x16x32_bf16 v[248:251], v[8:11], v[56:59], v[248:251]
    ds_read_b128 v[48:51], v130 offset:56320
    v_mfma_f32_16x16x32_bf16 v[252:255], v[12:15], v[56:59], v[252:255]
    s_waitcnt lgkmcnt(6)
    v_mfma_f32_16x16x32_bf16 v[184:187], v[16:19], v[24:27], v[184:187]
    ds_read_b128 v[52:55], v130 offset:57344
    v_mfma_f32_16x16x32_bf16 v[188:191], v[20:23], v[24:27], v[188:191]
    s_waitcnt lgkmcnt(6)
    v_mfma_f32_16x16x32_bf16 v[192:195], v[16:19], v[28:31], v[192:195]
    ds_read_b128 v[56:59], v130 offset:58368
    v_mfma_f32_16x16x32_bf16 v[196:199], v[20:23], v[28:31], v[196:199]
    s_waitcnt lgkmcnt(6)
    v_mfma_f32_16x16x32_bf16 v[200:203], v[16:19], v[32:35], v[200:203]
    v_mfma_f32_16x16x32_bf16 v[204:207], v[20:23], v[32:35], v[204:207]
    s_waitcnt lgkmcnt(5)
    v_mfma_f32_16x16x32_bf16 v[208:211], v[16:19], v[36:39], v[208:211]
    v_mfma_f32_16x16x32_bf16 v[212:215], v[20:23], v[36:39], v[212:215]
    buffer_load_dword v135, v133, s[36:39], s4 offen sc1
    s_waitcnt lgkmcnt(4)
    v_mfma_f32_16x16x32_bf16 v[216:219], v[16:19], v[40:43], v[216:219]
    v_mfma_f32_16x16x32_bf16 v[220:223], v[20:23], v[40:43], v[220:223]
    s_waitcnt lgkmcnt(3)
    v_mfma_f32_16x16x32_bf16 v[224:227], v[16:19], v[44:47], v[224:227]
    v_mfma_f32_16x16x32_bf16 v[228:231], v[20:23], v[44:47], v[228:231]
    s_waitcnt lgkmcnt(2)
    v_mfma_f32_16x16x32_bf16 v[232:235], v[16:19], v[48:51], v[232:235]
    v_mfma_f32_16x16x32_bf16 v[236:239], v[20:23], v[48:51], v[236:239]
    s_waitcnt lgkmcnt(1)
    v_mfma_f32_16x16x32_bf16 v[240:243], v[16:19], v[52:55], v[240:243]
    v_mfma_f32_16x16x32_bf16 v[244:247], v[20:23], v[52:55], v[244:247]
    s_waitcnt lgkmcnt(0)
    v_mfma_f32_16x16x32_bf16 v[248:251], v[16:19], v[56:59], v[248:251]
    v_mfma_f32_16x16x32_bf16 v[252:255], v[20:23], v[56:59], v[252:255]
    s_mov_b32 s63, 1
    s_waitcnt vmcnt(0)
    s_setprio 2
    s_cmp_lg_u32 s48, 0
    s_cbranch_scc1 GF_ZCAD
    s_mov_b32 s62, 0
GF_ZCA:
    v_cmp_ne_u32 vcc, v132, v135
    v_cmp_ge_u32 s[50:51], 1, v134
    s_nop 0
    s_cmp_eq_u64 vcc, 0
    s_cselect_b32 s48, 1, 0
    s_cbranch_scc1 GF_ZCAD
    buffer_load_dword v135, v133, s[36:39], s4 offen sc1
    s_and_b64 s[50:51], vcc, s[50:51]
    s_cbranch_scc0 GF_ZCAD
    s_add_u32 s62, s62, 1
    s_waitcnt vmcnt(0)
    s_cmp_lt_u32 s62, 0x40000
    s_cbranch_scc1 GF_ZCA
GF_ZCAD:
GF_GWA:
    ds_read_b32 v83, v82
    s_waitcnt lgkmcnt(0)
    v_cmp_gt_u32 vcc, s63, v83
    s_nop 1
    s_cbranch_vccnz GF_GWA
    s_mov_b32 s63, 2
    s_add_u32 m0, s60, 81920
    s_nop 0
    buffer_load_dwordx4 v124, s[28:31], s56 offen sc1 lds
    buffer_load_dwordx4 v124, s[28:31], s56 offen offset:1024 sc1 lds
    buffer_load_dwordx4 v124, s[28:31], s56 offen offset:2048 sc1 lds
    s_add_u32 m0, s61, 81920
    s_nop 0
    buffer_load_dwordx4 v124, s[28:31], s57 offen sc1 lds
    s_add_u32 s56, s56, s58
    buffer_load_dwordx4 v124, s[28:31], s57 offen offset:1024 sc1 lds
    buffer_load_dwordx4 v124, s[28:31], s57 offen offset:2048 sc1 lds
    s_add_u32 m0, s59, 81920
    s_nop 0
    buffer_load_dwordx4 v76, s[24:27], s54 offen lds
    s_add_u32 s57, s57, s58
    buffer_load_dwordx4 v77, s[24:27], s54 offen offset:1024 lds
    buffer_load_dwordx4 v78, s[24:27], s54 offen offset:2048 lds
    buffer_load_dwordx4 v79, s[24:27], s54 offen offset:3072 lds
    s_add_u32 s54, s54, 128
    s_add_u32 m0, s60, 122880
GF_GW1:
    s_sleep 1
    ds_read_b32 v83, v82
    s_waitcnt lgkmcnt(0)
    v_cmp_gt_u32 vcc, s63, v83
    s_nop 1
    s_cbranch_vccnz GF_GW1
    buffer_load_dwordx4 v124, s[28:31], s56 offen sc1 lds
    buffer_load_dwordx4 v124, s[28:31], s56 offen offset:1024 sc1 lds
    buffer_load_dwordx4 v124, s[28:31], s56 offen offset:2048 sc1 lds
    s_add_u32 m0, s61, 122880
    s_nop 0
    buffer_load_dwordx4 v124, s[28:31], s57 offen sc1 lds
    s_add_u32 s56, s56, s58
    buffer_load_dwordx4 v124, s[28:31], s57 offen offset:1024 sc1 lds
    buffer_load_dwordx4 v124, s[28:31], s57 offen offset:2048 sc1 lds
    s_add_u32 m0, s59, 122880
    s_nop 0
    buffer_load_dwordx4 v76, s[24:27], s54 offen lds
    s_add_u32 s57, s57, s58
    buffer_load_dwordx4 v77, s[24:27], s54 offen offset:1024 lds
    buffer_load_dwordx4 v78, s[24:27], s54 offen offset:2048 lds
    buffer_load_dwordx4 v79, s[24:27], s54 offen offset:3072 lds
    s_add_u32 s54, s54, 128
    s_add_u32 m0, s60, 0
    s_add_u32 s49, s46, 1
    s_and_b32 s46, s49, 15
    s_cmp_eq_u32 s46, s44
    s_addc_u32 s46, s46, 0
    s_and_b32 s46, s46, 15
    s_lshl_b32 s54, s46, 8
    s_sub_u32 s49, s46, s49
    s_mul_i32 s49, s49, s66
    s_add_u32 s56, s56, s49
    s_add_u32 s57, s57, s49
    s_waitcnt vmcnt(14)
    ds_add_u32 v84, v85
    s_mov_b32 s63, 3
    s_cmp_lg_u32 s48, 0
    s_cbranch_scc1 GF_ZCCD
    s_mov_b32 s62, 0
GF_ZCC:
    v_cmp_ne_u32 vcc, v132, v135
    v_cmp_ge_u32 s[50:51], 2, v134
    s_nop 0
    s_cmp_eq_u64 vcc, 0
    s_cselect_b32 s48, 1, 0
    s_cbranch_scc1 GF_ZCCD
    buffer_load_dword v135, v133, s[36:39], s4 offen sc1
    s_and_b64 s[50:51], vcc, s[50:51]
    s_cbranch_scc0 GF_ZCCD
    s_add_u32 s62, s62, 1
    s_waitcnt vmcnt(0)
    s_cmp_lt_u32 s62, 0x40000
    s_cbranch_scc1 GF_ZCC
GF_ZCCD:
GF_GW2:
    s_sleep 1
    ds_read_b32 v83, v82
    s_waitcnt lgkmcnt(0)
    v_cmp_gt_u32 vcc, s63, v83
    s_nop 1
    s_cbranch_vccnz GF_GW2
    s_waitcnt vmcnt(10)
    s_setprio 0
    ds_read_b128 v[8:11], v128 offset:0
    ds_read_b128 v[12:15], v128 offset:2048
    ds_read_b128 v[24:27], v131 offset:0
    buffer_load_dwordx4 v124, s[28:31], s56 offen sc1 lds
    ds_read_b128 v[28:31], v131 offset:1024
    ds_read_b128 v[32:35], v131 offset:2048
    buffer_load_dwordx4 v124, s[28:31], s56 offen offset:1024 sc1 lds
    ds_read_b128 v[36:39], v131 offset:3072
    ds_read_b128 v[40:43], v131 offset:4096
    buffer_load_dwordx4 v124, s[28:31], s56 offen offset:2048 sc1 lds
    s_add_u32 m0, s61, 0
    ds_read_b128 v[44:47], v131 offset:5120
    buffer_load_dwordx4 v124, s[28:31], s57 offen sc1 lds
    s_add_u32 s56, s56, s58
    ds_read_b128 v[48:51], v131 offset:6144
    s_mov_b32 s52, 0
    s_branch GF_GU2
GF_GL:
    s_waitcnt lgkmcnt(5)
    v_mfma_f32_16x16x32_bf16 v[184:187], v[8:11], v[24:27], v[184:187]
    ds_read_b128 v[52:55], v130 offset:7168
    v_mfma_f32_16x16x32_bf16 v[188:191], v[12:15], v[24:27], v[188:191]
    buffer_load_dwordx4 v124, s[28:31], s57 offen offset:1024 sc1 lds
    s_waitcnt vmcnt(9)
    ds_add_u32 v84, v85
    v_mfma_f32_16x16x32_bf16 v[192:195], v[8:11], v[28:31], v[192:195]
    ds_read_b128 v[56:59], v130 offset:8192
    v_mfma_f32_16x16x32_bf16 v[196:199], v[12:15], v[28:31], v[196:199]
    ds_read_b128 v[16:19], v127 offset:0
    ds_read_b128 v[20:23], v127 offset:2048
    s_waitcnt lgkmcnt(8)
    v_mfma_f32_16x16x32_bf16 v[200:203], v[8:11], v[32:35], v[200:203]
    ds_read_b128 v[24:27], v130 offset:9216
    v_mfma_f32_16x16x32_bf16 v[204:207], v[12:15], v[32:35], v[204:207]
    buffer_load_dwordx4 v124, s[28:31], s57 offen offset:2048 sc1 lds
    s_add_u32 m0, s59, 81920
    v_mfma_f32_16x16x32_bf16 v[208:211], v[8:11], v[36:39], v[208:211]
    ds_read_b128 v[28:31], v130 offset:10240
    v_mfma_f32_16x16x32_bf16 v[212:215], v[12:15], v[36:39], v[212:215]
    buffer_load_dwordx4 v76, s[24:27], s54 offen lds
    s_add_u32 s57, s57, s58
    s_waitcnt lgkmcnt(8)
    v_mfma_f32_16x16x32_bf16 v[216:219], v[8:11], v[40:43], v[216:219]
    ds_read_b128 v[32:35], v130 offset:11264
    v_mfma_f32_16x16x32_bf16 v[220:223], v[12:15], v[40:43], v[220:223]
    v_mfma_f32_16x16x32_bf16 v[224:227], v[8:11], v[44:47], v[224:227]
    ds_read_b128 v[36:39], v130 offset:12288
    v_mfma_f32_16x16x32_bf16 v[228:231], v[12:15], v[44:47], v[228:231]
    buffer_load_dwordx4 v77, s[24:27], s54 offen offset:1024 lds
    s_waitcnt lgkmcnt(8)
    v_mfma_f32_16x16x32_bf16 v[232:235], v[8:11], v[48:51], v[232:235]
    ds_read_b128 v[40:43], v130 offset:13312
    v_mfma_f32_16x16x32_bf16 v[236:239], v[12:15], v[48:51], v[236:239]
    v_mfma_f32_16x16x32_bf16 v[240:243], v[8:11], v[52:55], v[240:243]
    ds_read_b128 v[44:47], v130 offset:14336
    v_mfma_f32_16x16x32_bf16 v[244:247], v[12:15], v[52:55], v[244:247]
    buffer_load_dwordx4 v78, s[24:27], s54 offen offset:2048 lds
    ds_read_b32 v83, v82
    s_waitcnt lgkmcnt(6)
    v_mfma_f32_16x16x32_bf16 v[248:251], v[8:11], v[56:59], v[248:251]
    ds_read_b128 v[48:51], v130 offset:15360
    v_mfma_f32_16x16x32_bf16 v[252:255], v[12:15], v[56:59], v[252:255]
    v_mfma_f32_16x16x32_bf16 v[184:187], v[16:19], v[24:27], v[184:187]
    ds_read_b128 v[52:55], v130 offset:16384
    v_mfma_f32_16x16x32_bf16 v[188:191], v[20:23], v[24:27], v[188:191]
    buffer_load_dwordx4 v79, s[24:27], s54 offen offset:3072 lds
    s_add_u32 s54, s54, 128
    s_add_u32 m0, s60, 122880
    s_waitcnt lgkmcnt(6)
    v_mfma_f32_16x16x32_bf16 v[192:195], v[16:19], v[28:31], v[192:195]
    ds_read_b128 v[56:59], v130 offset:17408
    v_mfma_f32_16x16x32_bf16 v[196:199], v[20:23], v[28:31], v[196:199]
    s_waitcnt lgkmcnt(3)
    s_setprio 3
    v_cmp_ge_u32 vcc, s63, v83
    s_setprio 0
    s_add_u32 s63, s63, 1
    s_cbranch_vccnz GF_GSPIN0
GF_GBACK0:
    s_waitcnt vmcnt(10)
    ds_read_b128 v[8:11], v126 offset:40960
    ds_read_b128 v[12:15], v126 offset:43008
    v_mfma_f32_16x16x32_bf16 v[200:203], v[16:19], v[32:35], v[200:203]
    ds_read_b128 v[24:27], v130 offset:40960
    v_mfma_f32_16x16x32_bf16 v[204:207], v[20:23], v[32:35], v[204:207]
    buffer_load_dwordx4 v124, s[28:31], s56 offen sc1 lds
    v_mfma_f32_16x16x32_bf16 v[208:211], v[16:19], v[36:39], v[208:211]
    ds_read_b128 v[28:31], v130 offset:41984
    v_mfma_f32_16x16x32_bf16 v[212:215], v[20:23], v[36:39], v[212:215]
    v_mfma_f32_16x16x32_bf16 v[216:219], v[16:19], v[40:43], v[216:219]
    ds_read_b128 v[32:35], v130 offset:43008
    v_mfma_f32_16x16x32_bf16 v[220:223], v[20:23], v[40:43], v[220:223]
    buffer_load_dwordx4 v124, s[28:31], s56 offen offset:1024 sc1 lds
    s_waitcnt lgkmcnt(7)
    v_mfma_f32_16x16x32_bf16 v[224:227], v[16:19], v[44:47], v[224:227]
    ds_read_b128 v[36:39], v130 offset:44032
    v_mfma_f32_16x16x32_bf16 v[228:231], v[20:23], v[44:47], v[228:231]
    v_mfma_f32_16x16x32_bf16 v[232:235], v[16:19], v[48:51], v[232:235]
    ds_read_b128 v[40:43], v130 offset:45056
    v_mfma_f32_16x16x32_bf16 v[236:239], v[20:23], v[48:51], v[236:239]
    buffer_load_dwordx4 v124, s[28:31], s56 offen offset:2048 sc1 lds
    s_add_u32 m0, s61, 122880
    s_waitcnt lgkmcnt(7)
    v_mfma_f32_16x16x32_bf16 v[240:243], v[16:19], v[52:55], v[240:243]
    ds_read_b128 v[44:47], v130 offset:46080
    v_mfma_f32_16x16x32_bf16 v[244:247], v[20:23], v[52:55], v[244:247]
    buffer_load_dwordx4 v124, s[28:31], s57 offen sc1 lds
    s_add_u32 s56, s56, s58
    v_mfma_f32_16x16x32_bf16 v[248:251], v[16:19], v[56:59], v[248:251]
    ds_read_b128 v[48:51], v130 offset:47104
    v_mfma_f32_16x16x32_bf16 v[252:255], v[20:23], v[56:59], v[252:255]
    s_waitcnt lgkmcnt(5)
    v_mfma_f32_16x16x32_bf16 v[184:187], v[8:11], v[24:27], v[184:187]
    ds_read_b128 v[52:55], v130 offset:48128
    v_mfma_f32_16x16x32_bf16 v[188:191], v[12:15], v[24:27], v[188:191]
    buffer_load_dwordx4 v124, s[28:31], s57 offen offset:1024 sc1 lds
    s_waitcnt vmcnt(9)
    ds_add_u32 v84, v85
    v_mfma_f32_16x16x32_bf16 v[192:195], v[8:11], v[28:31], v[192:195]
    ds_read_b128 v[56:59], v130 offset:49152
    v_mfma_f32_16x16x32_bf16 v[196:199], v[12:15], v[28:31], v[196:199]
    ds_read_b128 v[16:19], v127 offset:40960
    ds_read_b128 v[20:23], v127 offset:43008
    s_waitcnt lgkmcnt(8)
    v_mfma_f32_16x16x32_bf16 v[200:203], v[8:11], v[32:35], v[200:203]
    ds_read_b128 v[24:27], v130 offset:50176
    v_mfma_f32_16x16x32_bf16 v[204:207], v[12:15], v[32:35], v[204:207]
    buffer_load_dwordx4 v124, s[28:31], s57 offen offset:2048 sc1 lds
    s_add_u32 m0, s59, 122880
    v_mfma_f32_16x16x32_bf16 v[208:211], v[8:11], v[36:39], v[208:211]
    ds_read_b128 v[28:31], v130 offset:51200
    v_mfma_f32_16x16x32_bf16 v[212:215], v[12:15], v[36:39], v[212:215]
    buffer_load_dwordx4 v76, s[24:27], s54 offen lds
    s_add_u32 s57, s57, s58
    s_waitcnt lgkmcnt(8)
    v_mfma_f32_16x16x32_bf16 v[216:219], v[8:11], v[40:43], v[216:219]
    ds_read_b128 v[32:35], v130 offset:52224
    v_mfma_f32_16x16x32_bf16 v[220:223], v[12:15], v[40:43], v[220:223]
    v_mfma_f32_16x16x32_bf16 v[224:227], v[8:11], v[44:47], v[224:227]
    ds_read_b128 v[36:39], v130 offset:53248
    v_mfma_f32_16x16x32_bf16 v[228:231], v[12:15], v[44:47], v[228:231]
    buffer_load_dwordx4 v77, s[24:27], s54 offen offset:1024 lds
    s_waitcnt lgkmcnt(8)
    v_mfma_f32_16x16x32_bf16 v[232:235], v[8:11], v[48:51], v[232:235]
    ds_read_b128 v[40:43], v130 offset:54272
    v_mfma_f32_16x16x32_bf16 v[236:239], v[12:15], v[48:51], v[236:239]
    v_mfma_f32_16x16x32_bf16 v[240:243], v[8:11], v[52:55], v[240:243]
    ds_read_b128 v[44:47], v130 offset:55296
    v_mfma_f32_16x16x32_bf16 v[244:247], v[12:15], v[52:55], v[244:247]
    buffer_load_dwordx4 v78, s[24:27], s54 offen offset:2048 lds
    ds_read_b32 v83, v82
    s_waitcnt lgkmcnt(6)
    v_mfma_f32_16x16x32_bf16 v[248:251], v[8:11], v[56:59], v[248:251]
    ds_read_b128 v[48:51], v130 offset:56320
    v_mfma_f32_16x16x32_bf16 v[252:255], v[12:15], v[56:59], v[252:255]
    v_mfma_f32_16x16x32_bf16 v[184:187], v[16:19], v[24:27], v[184:187]
    ds_read_b128 v[52:55], v130 offset:57344
    v_mfma_f32_16x16x32_bf16 v[188:191], v[20:23], v[24:27], v[188:191]
    buffer_load_dwordx4 v79, s[24:27], s54 offen offset:3072 lds
    s_add_u32 s54, s54, 128
    s_add_u32 m0, s60, 0
    s_add_u32 s49, s46, 1
    s_and_b32 s46, s49, 15
    s_cmp_eq_u32 s46, s44
    s_addc_u32 s46, s46, 0
    s_and_b32 s46, s46, 15
    s_lshl_b32 s54, s46, 8
    s_sub_u32 s49, s46, s49
    s_mul_i32 s49, s49, s66
    s_add_u32 s56, s56, s49
    s_add_u32 s57, s57, s49
    s_waitcnt lgkmcnt(6)
    v_mfma_f32_16x16x32_bf16 v[192:195], v[16:19], v[28:31], v[192:195]
    ds_read_b128 v[56:59], v130 offset:58368
    v_mfma_f32_16x16x32_bf16 v[196:199], v[20:23], v[28:31], v[196:199]
    s_branch GF_GONCE
GF_GONCEB:
    s_waitcnt lgkmcnt(3)
    s_setprio 3
    v_cmp_ge_u32 vcc, s63, v83
    s_setprio 0
    s_add_u32 s63, s63, 1
    s_cbranch_vccnz GF_GSPIN1
GF_GBACK1:
    s_waitcnt vmcnt(10)
    ds_read_b128 v[8:11], v128 offset:0
    ds_read_b128 v[12:15], v128 offset:2048
    v_mfma_f32_16x16x32_bf16 v[200:203], v[16:19], v[32:35], v[200:203]
    ds_read_b128 v[24:27], v131 offset:0
    v_mfma_f32_16x16x32_bf16 v[204:207], v[20:23], v[32:35], v[204:207]
    buffer_load_dwordx4 v124, s[28:31], s56 offen sc1 lds
    v_mfma_f32_16x16x32_bf16 v[208:211], v[16:19], v[36:39], v[208:211]
    ds_read_b128 v[28:31], v131 offset:1024
    v_mfma_f32_16x16x32_bf16 v[212:215], v[20:23], v[36:39], v[212:215]
    v_mfma_f32_16x16x32_bf16 v[216:219], v[16:19], v[40:43], v[216:219]
    ds_read_b128 v[32:35], v131 offset:2048
    v_mfma_f32_16x16x32_bf16 v[220:223], v[20:23], v[40:43], v[220:223]
    buffer_load_dwordx4 v124, s[28:31], s56 offen offset:1024 sc1 lds
    s_waitcnt lgkmcnt(7)
    v_mfma_f32_16x16x32_bf16 v[224:227], v[16:19], v[44:47], v[224:227]
    ds_read_b128 v[36:39], v131 offset:3072
    v_mfma_f32_16x16x32_bf16 v[228:231], v[20:23], v[44:47], v[228:231]
    v_mfma_f32_16x16x32_bf16 v[232:235], v[16:19], v[48:51], v[232:235]
    ds_read_b128 v[40:43], v131 offset:4096
    v_mfma_f32_16x16x32_bf16 v[236:239], v[20:23], v[48:51], v[236:239]
    buffer_load_dwordx4 v124, s[28:31], s56 offen offset:2048 sc1 lds
    s_add_u32 m0, s61, 0
    s_waitcnt lgkmcnt(7)
    v_mfma_f32_16x16x32_bf16 v[240:243], v[16:19], v[52:55], v[240:243]
    ds_read_b128 v[44:47], v131 offset:5120
    v_mfma_f32_16x16x32_bf16 v[244:247], v[20:23], v[52:55], v[244:247]
    buffer_load_dwordx4 v124, s[28:31], s57 offen sc1 lds
    s_add_u32 s56, s56, s58
    v_mfma_f32_16x16x32_bf16 v[248:251], v[16:19], v[56:59], v[248:251]
    ds_read_b128 v[48:51], v131 offset:6144
    v_mfma_f32_16x16x32_bf16 v[252:255], v[20:23], v[56:59], v[252:255]
GF_GU2:
    s_waitcnt lgkmcnt(5)
    v_mfma_f32_16x16x32_bf16 v[184:187], v[8:11], v[24:27], v[184:187]
    ds_read_b128 v[52:55], v131 offset:7168
    v_mfma_f32_16x16x32_bf16 v[188:191], v[12:15], v[24:27], v[188:191]
    buffer_load_dwordx4 v124, s[28:31], s57 offen offset:1024 sc1 lds
    s_waitcnt vmcnt(9)
    ds_add_u32 v84, v85
    v_mfma_f32_16x16x32_bf16 v[192:195], v[8:11], v[28:31], v[192:195]
    ds_read_b128 v[56:59], v131 offset:8192
    v_mfma_f32_16x16x32_bf16 v[196:199], v[12:15], v[28:31], v[196:199]
    ds_read_b128 v[16:19], v129 offset:0
    ds_read_b128 v[20:23], v129 offset:2048
    s_waitcnt lgkmcnt(8)
    v_mfma_f32_16x16x32_bf16 v[200:203], v[8:11], v[32:35], v[200:203]
    ds_read_b128 v[24:27], v131 offset:9216
    v_mfma_f32_16x16x32_bf16 v[204:207], v[12:15], v[32:35], v[204:207]
    buffer_load_dwordx4 v124, s[28:31], s57 offen offset:2048 sc1 lds
    s_add_u32 m0, s59, 0
    v_mfma_f32_16x16x32_bf16 v[208:211], v[8:11], v[36:39], v[208:211]
    ds_read_b128 v[28:31], v131 offset:10240
    v_mfma_f32_16x16x32_bf16 v[212:215], v[12:15], v[36:39], v[212:215]
    buffer_load_dwordx4 v76, s[24:27], s54 offen lds
    s_add_u32 s57, s57, s58
    s_waitcnt lgkmcnt(8)
    v_mfma_f32_16x16x32_bf16 v[216:219], v[8:11], v[40:43], v[216:219]
    ds_read_b128 v[32:35], v131 offset:11264
    v_mfma_f32_16x16x32_bf16 v[220:223], v[12:15], v[40:43], v[220:223]
    v_mfma_f32_16x16x32_bf16 v[224:227], v[8:11], v[44:47], v[224:227]
    ds_read_b128 v[36:39], v131 offset:12288
    v_mfma_f32_16x16x32_bf16 v[228:231], v[12:15], v[44:47], v[228:231]
    buffer_load_dwordx4 v77, s[24:27], s54 offen offset:1024 lds
    s_waitcnt lgkmcnt(8)
    v_mfma_f32_16x16x32_bf16 v[232:235], v[8:11], v[48:51], v[232:235]
    ds_read_b128 v[40:43], v131 offset:13312
    v_mfma_f32_16x16x32_bf16 v[236:239], v[12:15], v[48:51], v[236:239]
    v_mfma_f32_16x16x32_bf16 v[240:243], v[8:11], v[52:55], v[240:243]
    ds_read_b128 v[44:47], v131 offset:14336
    v_mfma_f32_16x16x32_bf16 v[244:247], v[12:15], v[52:55], v[244:247]
    buffer_load_dwordx4 v78, s[24:27], s54 offen offset:2048 lds
    ds_read_b32 v83, v82
    s_waitcnt lgkmcnt(6)
    v_mfma_f32_16x16x32_bf16 v[248:251], v[8:11], v[56:59], v[248:251]
    ds_read_b128 v[48:51], v131 offset:15360
    v_mfma_f32_16x16x32_bf16 v[252:255], v[12:15], v[56:59], v[252:255]
    v_mfma_f32_16x16x32_bf16 v[184:187], v[16:19], v[24:27], v[184:187]
    ds_read_b128 v[52:55], v131 offset:16384
    v_mfma_f32_16x16x32_bf16 v[188:191], v[20:23], v[24:27], v[188:191]
    buffer_load_dwordx4 v79, s[24:27], s54 offen offset:3072 lds
    s_add_u32 s54, s54, 128
    s_add_u32 m0, s60, 40960
    s_waitcnt lgkmcnt(6)
    v_mfma_f32_16x16x32_bf16 v[192:195], v[16:19], v[28:31], v[192:195]
    ds_read_b128 v[56:59], v131 offset:17408
    v_mfma_f32_16x16x32_bf16 v[196:199], v[20:23], v[28:31], v[196:199]
    s_waitcnt lgkmcnt(3)
    s_setprio 3
    v_cmp_ge_u32 vcc, s63, v83
    s_setprio 0
    s_add_u32 s63, s63, 1
    s_cbranch_vccnz GF_GSPIN2
GF_GBACK2:
    s_waitcnt vmcnt(10)
    ds_read_b128 v[8:11], v128 offset:40960
    ds_read_b128 v[12:15], v128 offset:43008
    v_mfma_f32_16x16x32_bf16 v[200:203], v[16:19], v[32:35], v[200:203]
    ds_read_b128 v[24:27], v131 offset:40960
    v_mfma_f32_16x16x32_bf16 v[204:207], v[20:23], v[32:35], v[204:207]
    buffer_load_dwordx4 v124, s[28:31], s56 offen sc1 lds
    v_mfma_f32_16x16x32_bf16 v[208:211], v[16:19], v[36:39], v[208:211]
    ds_read_b128 v[28:31], v131 offset:41984
    v_mfma_f32_16x16x32_bf16 v[212:215], v[20:23], v[36:39], v[212:215]
    v_mfma_f32_16x16x32_bf16 v[216:219], v[16:19], v[40:43], v[216:219]
    ds_read_b128 v[32:35], v131 offset:43008
    v_mfma_f32_16x16x32_bf16 v[220:223], v[20:23], v[40:43], v[220:223]
    buffer_load_dwordx4 v124, s[28:31], s56 offen offset:1024 sc1 lds
    s_waitcnt lgkmcnt(7)
    v_mfma_f32_16x16x32_bf16 v[224:227], v[16:19], v[44:47], v[224:227]
    ds_read_b128 v[36:39], v131 offset:44032
    v_mfma_f32_16x16x32_bf16 v[228:231], v[20:23], v[44:47], v[228:231]
    v_mfma_f32_16x16x32_bf16 v[232:235], v[16:19], v[48:51], v[232:235]
    ds_read_b128 v[40:43], v131 offset:45056
    v_mfma_f32_16x16x32_bf16 v[236:239], v[20:23], v[48:51], v[236:239]
    buffer_load_dwordx4 v124, s[28:31], s56 offen offset:2048 sc1 lds
    s_add_u32 m0, s61, 40960
    s_waitcnt lgkmcnt(7)
    v_mfma_f32_16x16x32_bf16 v[240:243], v[16:19], v[52:55], v[240:243]
    ds_read_b128 v[44:47], v131 offset:46080
    v_mfma_f32_16x16x32_bf16 v[244:247], v[20:23], v[52:55], v[244:247]
    buffer_load_dwordx4 v124, s[28:31], s57 offen sc1 lds
    s_add_u32 s56, s56, s58
    v_mfma_f32_16x16x32_bf16 v[248:251], v[16:19], v[56:59], v[248:251]
    ds_read_b128 v[48:51], v131 offset:47104
    v_mfma_f32_16x16x32_bf16 v[252:255], v[20:23], v[56:59], v[252:255]
    s_waitcnt lgkmcnt(5)
    v_mfma_f32_16x16x32_bf16 v[184:187], v[8:11], v[24:27], v[184:187]
    ds_read_b128 v[52:55], v131 offset:48128
    v_mfma_f32_16x16x32_bf16 v[188:191], v[12:15], v[24:27], v[188:191]
    buffer_load_dwordx4 v124, s[28:31], s57 offen offset:1024 sc1 lds
    s_waitcnt vmcnt(9)
    ds_add_u32 v84, v85
    v_mfma_f32_16x16x32_bf16 v[192:195], v[8:11], v[28:31], v[192:195]
    ds_read_b128 v[56:59], v131 offset:49152
    v_mfma_f32_16x16x32_bf16 v[196:199], v[12:15], v[28:31], v[196:199]
    ds_read_b128 v[16:19], v129 offset:40960
    ds_read_b128 v[20:23], v129 offset:43008
    s_waitcnt lgkmcnt(8)
    v_mfma_f32_16x16x32_bf16 v[200:203], v[8:11], v[32:35], v[200:203]
    ds_read_b128 v[24:27], v131 offset:50176
    v_mfma_f32_16x16x32_bf16 v[204:207], v[12:15], v[32:35], v[204:207]
    buffer_load_dwordx4 v124, s[28:31], s57 offen offset:2048 sc1 lds
    s_add_u32 m0, s59, 40960
    v_mfma_f32_16x16x32_bf16 v[208:211], v[8:11], v[36:39], v[208:211]
    ds_read_b128 v[28:31], v131 offset:51200
    v_mfma_f32_16x16x32_bf16 v[212:215], v[12:15], v[36:39], v[212:215]
    buffer_load_dwordx4 v76, s[24:27], s54 offen lds
    s_add_u32 s57, s57, s58
    s_waitcnt lgkmcnt(8)
    v_mfma_f32_16x16x32_bf16 v[216:219], v[8:11], v[40:43], v[216:219]
    ds_read_b128 v[32:35], v131 offset:52224
    v_mfma_f32_16x16x32_bf16 v[220:223], v[12:15], v[40:43], v[220:223]
    v_mfma_f32_16x16x32_bf16 v[224:227], v[8:11], v[44:47], v[224:227]
    ds_read_b128 v[36:39], v131 offset:53248
    v_mfma_f32_16x16x32_bf16 v[228:231], v[12:15], v[44:47], v[228:231]
    buffer_load_dwordx4 v77, s[24:27], s54 offen offset:1024 lds
    s_waitcnt lgkmcnt(8)
    v_mfma_f32_16x16x32_bf16 v[232:235], v[8:11], v[48:51], v[232:235]
    ds_read_b128 v[40:43], v131 offset:54272
    v_mfma_f32_16x16x32_bf16 v[236:239], v[12:15], v[48:51], v[236:239]
    v_mfma_f32_16x16x32_bf16 v[240:243], v[8:11], v[52:55], v[240:243]
    ds_read_b128 v[44:47], v131 offset:55296
    v_mfma_f32_16x16x32_bf16 v[244:247], v[12:15], v[52:55], v[244:247]
    buffer_load_dwordx4 v78, s[24:27], s54 offen offset:2048 lds
    ds_read_b32 v83, v82
    s_waitcnt lgkmcnt(6)
    v_mfma_f32_16x16x32_bf16 v[248:251], v[8:11], v[56:59], v[248:251]
    ds_read_b128 v[48:51], v131 offset:56320
    v_mfma_f32_16x16x32_bf16 v[252:255], v[12:15], v[56:59], v[252:255]
    v_mfma_f32_16x16x32_bf16 v[184:187], v[16:19], v[24:27], v[184:187]
    ds_read_b128 v[52:55], v131 offset:57344
    v_mfma_f32_16x16x32_bf16 v[188:191], v[20:23], v[24:27], v[188:191]
    buffer_load_dwordx4 v79, s[24:27], s54 offen offset:3072 lds
    s_add_u32 s54, s54, 128
    s_add_u32 m0, s60, 81920
    s_add_u32 s49, s46, 1
    s_and_b32 s46, s49, 15
    s_cmp_eq_u32 s46, s44
    s_addc_u32 s46, s46, 0
    s_and_b32 s46, s46, 15
    s_lshl_b32 s54, s46, 8
    s_sub_u32 s49, s46, s49
    s_mul_i32 s49, s49, s66
    s_add_u32 s56, s56, s49
    s_add_u32 s57, s57, s49
    s_waitcnt lgkmcnt(6)
    v_mfma_f32_16x16x32_bf16 v[192:195], v[16:19], v[28:31], v[192:195]
    ds_read_b128 v[56:59], v131 offset:58368
    v_mfma_f32_16x16x32_bf16 v[196:199], v[20:23], v[28:31], v[196:199]
    s_cmp_eq_u32 s48, 0
    s_cbranch_scc1 GF_GON3
GF_GON3B:
    s_waitcnt lgkmcnt(3)
    s_setprio 3
    v_cmp_ge_u32 vcc, s63, v83
    s_setprio 0
    s_add_u32 s63, s63, 1
    s_cbranch_vccnz GF_GSPIN3
GF_GBACK3:
    s_waitcnt vmcnt(10)
    ds_read_b128 v[8:11], v126 offset:0
    ds_read_b128 v[12:15], v126 offset:2048
    v_mfma_f32_16x16x32_bf16 v[200:203], v[16:19], v[32:35], v[200:203]
    ds_read_b128 v[24:27], v130 offset:0
    v_mfma_f32_16x16x32_bf16 v[204:207], v[20:23], v[32:35], v[204:207]
    buffer_load_dwordx4 v124, s[28:31], s56 offen sc1 lds
    v_mfma_f32_16x16x32_bf16 v[208:211], v[16:19], v[36:39], v[208:211]
    ds_read_b128 v[28:31], v130 offset:1024
    v_mfma_f32_16x16x32_bf16 v[212:215], v[20:23], v[36:39], v[212:215]
    v_mfma_f32_16x16x32_bf16 v[216:219], v[16:19], v[40:43], v[216:219]
    ds_read_b128 v[32:35], v130 offset:2048
    v_mfma_f32_16x16x32_bf16 v[220:223], v[20:23], v[40:43], v[220:223]
    buffer_load_dwordx4 v124, s[28:31], s56 offen offset:1024 sc1 lds
    s_waitcnt lgkmcnt(7)
    v_mfma_f32_16x16x32_bf16 v[224:227], v[16:19], v[44:47], v[224:227]
    ds_read_b128 v[36:39], v130 offset:3072
    v_mfma_f32_16x16x32_bf16 v[228:231], v[20:23], v[44:47], v[228:231]
    v_mfma_f32_16x16x32_bf16 v[232:235], v[16:19], v[48:51], v[232:235]
    ds_read_b128 v[40:43], v130 offset:4096
    v_mfma_f32_16x16x32_bf16 v[236:239], v[20:23], v[48:51], v[236:239]
    buffer_load_dwordx4 v124, s[28:31], s56 offen offset:2048 sc1 lds
    s_add_u32 m0, s61, 81920
    s_waitcnt lgkmcnt(7)
    v_mfma_f32_16x16x32_bf16 v[240:243], v[16:19], v[52:55], v[240:243]
    ds_read_b128 v[44:47], v130 offset:5120
    v_mfma_f32_16x16x32_bf16 v[244:247], v[20:23], v[52:55], v[244:247]
    buffer_load_dwordx4 v124, s[28:31], s57 offen sc1 lds
    s_add_u32 s56, s56, s58
    v_mfma_f32_16x16x32_bf16 v[248:251], v[16:19], v[56:59], v[248:251]
    ds_read_b128 v[48:51], v130 offset:6144
    v_mfma_f32_16x16x32_bf16 v[252:255], v[20:23], v[56:59], v[252:255]
    s_add_u32 s52, s52, 1
    s_cmp_lt_u32 s52, 8
    s_cbranch_scc1 GF_GL
    s_waitcnt vmcnt(0) lgkmcnt(0)
    v_mov_b32 v83, 163008
    s_setprio 2
    s_load_dwordx2 s[8:9], s[0:1], 88
    s_mov_b32 s62, 0
GF_OGC:
    s_mov_b64 s[58:59], -1
    v_cmp_eq_u32 vcc, v132, v61
    v_mov_b32 v160, v60
    s_nop 0
    s_and_b64 s[58:59], s[58:59], vcc
    v_cmp_eq_u32 vcc, v132, v63
    v_mov_b32 v161, v62
    s_nop 0
    s_and_b64 s[58:59], s[58:59], vcc
    v_cmp_eq_u32 vcc, v132, v65
    v_mov_b32 v162, v64
    s_nop 0
    s_and_b64 s[58:59], s[58:59], vcc
    v_cmp_eq_u32 vcc, v132, v67
    v_mov_b32 v163, v66
    s_nop 0
    s_and_b64 s[58:59], s[58:59], vcc
    v_cmp_eq_u32 vcc, v132, v69
    v_mov_b32 v164, v68
    s_nop 0
    s_and_b64 s[58:59], s[58:59], vcc
    v_cmp_eq_u32 vcc, v132, v71
    v_mov_b32 v165, v70
    s_nop 0
    s_and_b64 s[58:59], s[58:59], vcc
    v_cmp_eq_u32 vcc, v132, v73
    v_mov_b32 v166, v72
    s_nop 0
    s_and_b64 s[58:59], s[58:59], vcc
    v_cmp_eq_u32 vcc, v132, v75
    v_mov_b32 v167, v74
    s_nop 0
    s_and_b64 s[58:59], s[58:59], vcc
    s_cmp_eq_u64 s[58:59], -1
    s_cbranch_scc0 GF_OGR
GF_OGK:
    s_mul_i32 s4, s3, 144
    s_mul_i32 s5, s45, 9
    s_add_u32 s4, s4, s5
    s_lshl_b32 s4, s4, 10
    s_add_u32 s4, s4, 24379392
    s_add_u32 s5, s4, 4096
    s_add_u32 s6, s4, 8192
    v_bfe_u32 v1, v0, 4, 1
    v_lshlrev_b32 v1, 7, v1
    v_xor_b32 v1, v1, v124
    v_lshlrev_b32 v152, 16, v168
    v_and_b32 v153, 0xffff0000, v168
    v_lshlrev_b32 v154, 16, v169
    v_and_b32 v155, 0xffff0000, v169
    v_lshlrev_b32 v156, 16, v170
    v_and_b32 v157, 0xffff0000, v170
    v_lshlrev_b32 v158, 16, v171
    v_and_b32 v159, 0xffff0000, v171
    v_pk_mul_f32 v[152:153], v[152:153], v[160:161]
    v_pk_mul_f32 v[154:155], v[154:155], v[162:163]
    v_pk_mul_f32 v[156:157], v[156:157], v[164:165]
    v_pk_mul_f32 v[158:159], v[158:159], v[166:167]
    v_lshlrev_b32 v8, 16, v88
    v_and_b32 v9, 0xffff0000, v88
    v_lshlrev_b32 v10, 16, v89
    v_and_b32 v11, 0xffff0000, v89
    v_lshlrev_b32 v12, 16, v90
    v_and_b32 v13, 0xffff0000, v90
    v_lshlrev_b32 v14, 16, v91
    v_and_b32 v15, 0xffff0000, v91
    v_pk_fma_f32 v[184:185], v[184:185], v[160:161], v[152:153]
    v_pk_fma_f32 v[186:187], v[186:187], v[162:163], v[154:155]
    v_pk_fma_f32 v[188:189], v[188:189], v[164:165], v[156:157]
    v_pk_fma_f32 v[190:191], v[190:191], v[166:167], v[158:159]
    v_pk_mul_f32 v[184:185], v[184:185], v[8:9]
    v_pk_mul_f32 v[186:187], v[186:187], v[10:11]
    v_pk_mul_f32 v[188:189], v[188:189], v[12:13]
    v_pk_mul_f32 v[190:191], v[190:191], v[14:15]
    v_cvt_pk_bf16_f32 v88, v184, v185
    v_cvt_pk_bf16_f32 v89, v186, v187
    v_cvt_pk_bf16_f32 v90, v188, v189
    v_cvt_pk_bf16_f32 v91, v190, v191
    buffer_store_dwordx4 v[88:91], v1, s[36:39], s4 offen offset:0 sc1
    v_lshlrev_b32 v16, 16, v92
    v_and_b32 v17, 0xffff0000, v92
    v_lshlrev_b32 v18, 16, v93
    v_and_b32 v19, 0xffff0000, v93
    v_lshlrev_b32 v20, 16, v94
    v_and_b32 v21, 0xffff0000, v94
    v_lshlrev_b32 v22, 16, v95
    v_and_b32 v23, 0xffff0000, v95
    v_pk_fma_f32 v[192:193], v[192:193], v[160:161], v[152:153]
    v_pk_fma_f32 v[194:195], v[194:195], v[162:163], v[154:155]
    v_pk_fma_f32 v[196:197], v[196:197], v[164:165], v[156:157]
    v_pk_fma_f32 v[198:199], v[198:199], v[166:167], v[158:159]
    v_pk_mul_f32 v[192:193], v[192:193], v[16:17]
    v_pk_mul_f32 v[194:195], v[194:195], v[18:19]
    v_pk_mul_f32 v[196:197], v[196:197], v[20:21]
    v_pk_mul_f32 v[198:199], v[198:199], v[22:23]
    v_cvt_pk_bf16_f32 v92, v192, v193
    v_cvt_pk_bf16_f32 v93, v194, v195
    v_cvt_pk_bf16_f32 v94, v196, v197
    v_cvt_pk_bf16_f32 v95, v198, v199
    buffer_store_dwordx4 v[92:95], v1, s[36:39], s4 offen offset:1024 sc1
    v_lshlrev_b32 v8, 16, v96
    v_and_b32 v9, 0xffff0000, v96
    v_lshlrev_b32 v10, 16, v97
    v_and_b32 v11, 0xffff0000, v97
    v_lshlrev_b32 v12, 16, v98
    v_and_b32 v13, 0xffff0000, v98
    v_lshlrev_b32 v14, 16, v99
    v_and_b32 v15, 0xffff0000, v99
    v_pk_fma_f32 v[200:201], v[200:201], v[160:161], v[152:153]
    v_pk_fma_f32 v[202:203], v[202:203], v[162:163], v[154:155]
    v_pk_fma_f32 v[204:205], v[204:205], v[164:165], v[156:157]
    v_pk_fma_f32 v[206:207], v[206:207], v[166:167], v[158:159]
    v_pk_mul_f32 v[200:201], v[200:201], v[8:9]
    v_pk_mul_f32 v[202:203], v[202:203], v[10:11]
    v_pk_mul_f32 v[204:205], v[204:205], v[12:13]
    v_pk_mul_f32 v[206:207], v[206:207], v[14:15]
    v_cvt_pk_bf16_f32 v96, v200, v201
    v_cvt_pk_bf16_f32 v97, v202, v203
    v_cvt_pk_bf16_f32 v98, v204, v205
    v_cvt_pk_bf16_f32 v99, v206, v207
    buffer_store_dwordx4 v[96:99], v1, s[36:39], s4 offen offset:2048 sc1
    v_lshlrev_b32 v16, 16, v100
    v_and_b32 v17, 0xffff0000, v100
    v_lshlrev_b32 v18, 16, v101
    v_and_b32 v19, 0xffff0000, v101
    v_lshlrev_b32 v20, 16, v102
    v_and_b32 v21, 0xffff0000, v102
    v_lshlrev_b32 v22, 16, v103
    v_and_b32 v23, 0xffff0000, v103
    v_pk_fma_f32 v[208:209], v[208:209], v[160:161], v[152:153]
    v_pk_fma_f32 v[210:211], v[210:211], v[162:163], v[154:155]
    v_pk_fma_f32 v[212:213], v[212:213], v[164:165], v[156:157]
    v_pk_fma_f32 v[214:215], v[214:215], v[166:167], v[158:159]
    v_pk_mul_f32 v[208:209], v[208:209], v[16:17]
    v_pk_mul_f32 v[210:211], v[210:211], v[18:19]
    v_pk_mul_f32 v[212:213], v[212:213], v[20:21]
    v_pk_mul_f32 v[214:215], v[214:215], v[22:23]
    v_cvt_pk_bf16_f32 v100, v208, v209
    v_cvt_pk_bf16_f32 v101, v210, v211
    v_cvt_pk_bf16_f32 v102, v212, v213
    v_cvt_pk_bf16_f32 v103, v214, v215
    buffer_store_dwordx4 v[100:103], v1, s[36:39], s4 offen offset:3072 sc1
    v_lshlrev_b32 v8, 16, v104
    v_and_b32 v9, 0xffff0000, v104
    v_lshlrev_b32 v10, 16, v105
    v_and_b32 v11, 0xffff0000, v105
    v_lshlrev_b32 v12, 16, v106
    v_and_b32 v13, 0xffff0000, v106
    v_lshlrev_b32 v14, 16, v107
    v_and_b32 v15, 0xffff0000, v107
    v_pk_fma_f32 v[216:217], v[216:217], v[160:161], v[152:153]
    v_pk_fma_f32 v[218:219], v[218:219], v[162:163], v[154:155]
    v_pk_fma_f32 v[220:221], v[220:221], v[164:165], v[156:157]
    v_pk_fma_f32 v[222:223], v[222:223], v[166:167], v[158:159]
    v_pk_mul_f32 v[216:217], v[216:217], v[8:9]
    v_pk_mul_f32 v[218:219], v[218:219], v[10:11]
    v_pk_mul_f32 v[220:221], v[220:221], v[12:13]
    v_pk_mul_f32 v[222:223], v[222:223], v[14:15]
    v_cvt_pk_bf16_f32 v104, v216, v217
    v_cvt_pk_bf16_f32 v105, v218, v219
    v_cvt_pk_bf16_f32 v106, v220, v221
    v_cvt_pk_bf16_f32 v107, v222, v223
    buffer_store_dwordx4 v[104:107], v1, s[36:39], s5 offen offset:0 sc1
    v_lshlrev_b32 v16, 16, v108
    v_and_b32 v17, 0xffff0000, v108
    v_lshlrev_b32 v18, 16, v109
    v_and_b32 v19, 0xffff0000, v109
    v_lshlrev_b32 v20, 16, v110
    v_and_b32 v21, 0xffff0000, v110
    v_lshlrev_b32 v22, 16, v111
    v_and_b32 v23, 0xffff0000, v111
    v_pk_fma_f32 v[224:225], v[224:225], v[160:161], v[152:153]
    v_pk_fma_f32 v[226:227], v[226:227], v[162:163], v[154:155]
    v_pk_fma_f32 v[228:229], v[228:229], v[164:165], v[156:157]
    v_pk_fma_f32 v[230:231], v[230:231], v[166:167], v[158:159]
    v_pk_mul_f32 v[224:225], v[224:225], v[16:17]
    v_pk_mul_f32 v[226:227], v[226:227], v[18:19]
    v_pk_mul_f32 v[228:229], v[228:229], v[20:21]
    v_pk_mul_f32 v[230:231], v[230:231], v[22:23]
    v_cvt_pk_bf16_f32 v108, v224, v225
    v_cvt_pk_bf16_f32 v109, v226, v227
    v_cvt_pk_bf16_f32 v110, v228, v229
    v_cvt_pk_bf16_f32 v111, v230, v231
    buffer_store_dwordx4 v[108:111], v1, s[36:39], s5 offen offset:1024 sc1
    v_lshlrev_b32 v8, 16, v112
    v_and_b32 v9, 0xffff0000, v112
    v_lshlrev_b32 v10, 16, v113
    v_and_b32 v11, 0xffff0000, v113
    v_lshlrev_b32 v12, 16, v114
    v_and_b32 v13, 0xffff0000, v114
    v_lshlrev_b32 v14, 16, v115
    v_and_b32 v15, 0xffff0000, v115
    v_pk_fma_f32 v[232:233], v[232:233], v[160:161], v[152:153]
    v_pk_fma_f32 v[234:235], v[234:235], v[162:163], v[154:155]
    v_pk_fma_f32 v[236:237], v[236:237], v[164:165], v[156:157]
    v_pk_fma_f32 v[238:239], v[238:239], v[166:167], v[158:159]
    v_pk_mul_f32 v[232:233], v[232:233], v[8:9]
    v_pk_mul_f32 v[234:235], v[234:235], v[10:11]
    v_pk_mul_f32 v[236:237], v[236:237], v[12:13]
    v_pk_mul_f32 v[238:239], v[238:239], v[14:15]
    v_cvt_pk_bf16_f32 v112, v232, v233
    v_cvt_pk_bf16_f32 v113, v234, v235
    v_cvt_pk_bf16_f32 v114, v236, v237
    v_cvt_pk_bf16_f32 v115, v238, v239
    buffer_store_dwordx4 v[112:115], v1, s[36:39], s5 offen offset:2048 sc1
    v_lshlrev_b32 v16, 16, v116
    v_and_b32 v17, 0xffff0000, v116
    v_lshlrev_b32 v18, 16, v117
    v_and_b32 v19, 0xffff0000, v117
    v_lshlrev_b32 v20, 16, v118
    v_and_b32 v21, 0xffff0000, v118
    v_lshlrev_b32 v22, 16, v119
    v_and_b32 v23, 0xffff0000, v119
    v_pk_fma_f32 v[240:241], v[240:241], v[160:161], v[152:153]
    v_pk_fma_f32 v[242:243], v[242:243], v[162:163], v[154:155]
    v_pk_fma_f32 v[244:245], v[244:245], v[164:165], v[156:157]
    v_pk_fma_f32 v[246:247], v[246:247], v[166:167], v[158:159]
    v_pk_mul_f32 v[240:241], v[240:241], v[16:17]
    v_pk_mul_f32 v[242:243], v[242:243], v[18:19]
    v_pk_mul_f32 v[244:245], v[244:245], v[20:21]
    v_pk_mul_f32 v[246:247], v[246:247], v[22:23]
    v_cvt_pk_bf16_f32 v116, v240, v241
    v_cvt_pk_bf16_f32 v117, v242, v243
    v_cvt_pk_bf16_f32 v118, v244, v245
    v_cvt_pk_bf16_f32 v119, v246, v247
    buffer_store_dwordx4 v[116:119], v1, s[36:39], s5 offen offset:3072 sc1
    v_lshlrev_b32 v8, 16, v120
    v_and_b32 v9, 0xffff0000, v120
    v_lshlrev_b32 v10, 16, v121
    v_and_b32 v11, 0xffff0000, v121
    v_lshlrev_b32 v12, 16, v122
    v_and_b32 v13, 0xffff0000, v122
    v_lshlrev_b32 v14, 16, v123
    v_and_b32 v15, 0xffff0000, v123
    v_pk_fma_f32 v[248:249], v[248:249], v[160:161], v[152:153]
    v_pk_fma_f32 v[250:251], v[250:251], v[162:163], v[154:155]
    v_pk_fma_f32 v[252:253], v[252:253], v[164:165], v[156:157]
    v_pk_fma_f32 v[254:255], v[254:255], v[166:167], v[158:159]
    v_pk_mul_f32 v[248:249], v[248:249], v[8:9]
    v_pk_mul_f32 v[250:251], v[250:251], v[10:11]
    v_pk_mul_f32 v[252:253], v[252:253], v[12:13]
    v_pk_mul_f32 v[254:255], v[254:255], v[14:15]
    v_cvt_pk_bf16_f32 v120, v248, v249
    v_cvt_pk_bf16_f32 v121, v250, v251
    v_cvt_pk_bf16_f32 v122, v252, v253
    v_cvt_pk_bf16_f32 v123, v254, v255
    buffer_store_dwordx4 v[120:123], v1, s[36:39], s6 offen offset:0 sc1
    s_mov_b64 exec, 1
    ds_add_u32 v83, v85
    s_mov_b64 exec, -1
    s_lshl_b32 s5, s3, 6
    s_lshl_b32 s4, s45, 2
    s_add_u32 s5, s5, s4
    s_add_u32 s5, s5, 41209856
    s_and_b32 s46, s2, 7
    s_lshr_b32 s48, s2, 3
    s_mul_i32 s46, s46, 30
    s_add_u32 s46, s46, s48
    s_cmp_ge_u32 s48, 30
    s_cselect_b32 s46, 999, s46
    s_mul_i32 s44, s46, 7282
    s_lshr_b32 s44, s44, 16
    s_mul_i32 s48, s44, 9
    s_sub_u32 s45, s46, s48
    s_mul_i32 s44, s44, 5
    s_min_u32 s44, s44, 123
    s_mov_b32 s53, 18432
    v_bfe_u32 v5, v0, 2, 2
    v_and_b32 v6, 3, v0
    v_and_b32 v1, 15, v0
    v_bfe_u32 v2, v0, 1, 3
    v_xor_b32 v2, v2, v4
    v_lshlrev_b32 v2, 4, v2
    v_lshl_add_u32 v8, v1, 7, v2
    v_xor_b32 v9, 64, v8
    v_lshl_add_u32 v2, v4, 2, v5
    v_lshrrev_b32 v12, 1, v6
    v_lshlrev_b32 v7, 3, v12
    v_xor_b32 v7, v7, v2
    v_lshlrev_b32 v7, 4, v7
    v_lshl_add_u32 v7, v12, 8, v7
    v_and_b32 v12, 1, v6
    v_lshl_add_u32 v10, v12, 3, v7
    v_bfe_u32 v12, v2, 1, 2
    v_xor_b32 v12, s47, v12
    v_lshlrev_b32 v12, 5, v12
    v_lshl_add_u32 v12, v2, 7, v12
    v_lshl_add_u32 v12, v6, 3, v12
    v_add_u32 v11, 10240, v12
    v_mov_b32 v16, 0
    v_mov_b32 v17, 0
    v_mov_b32 v18, 0
    v_mov_b32 v19, 0
    v_mov_b32 v20, 0
    v_mov_b32 v21, 0
    v_mov_b32 v22, 0
    v_mov_b32 v23, 0
    v_mov_b32 v24, 0
    v_mov_b32 v25, 0
    v_mov_b32 v26, 0
    v_mov_b32 v27, 0
    v_mov_b32 v28, 0
    v_mov_b32 v29, 0
    v_mov_b32 v30, 0
    v_mov_b32 v31, 0
    v_mov_b32 v32, 0
    v_mov_b32 v33, 0
    v_mov_b32 v34, 0
    v_mov_b32 v35, 0
    s_waitcnt lgkmcnt(0)
    s_mov_b32 s24, s8
    s_mov_b32 s25, s9
    s_mov_b32 s26, 2359296
    s_mov_b32 s27, 0x00020000
    s_waitcnt vmcnt(0)
    s_mov_b64 exec, 1
    buffer_store_dword v132, v3, s[36:39], s5 offen sc1
    s_mov_b64 exec, -1
    s_cmp_ge_u32 s46, 234
    s_cbranch_scc1 GF_END
    s_mov_b32 s51, 0
    s_mov_b32 s52, 8
    s_barrier
    ds_read_b64_tr_b16 v[40:41], v11 offset:0
    ds_read_b64_tr_b16 v[42:43], v11 offset:2048
    ds_read_b128 v[44:47], v8 offset:0
    ds_read_b128 v[48:51], v8 offset:2048
    ds_read_b128 v[52:55], v8 offset:4096
    ds_read_b128 v[56:59], v8 offset:6144
    ds_read_b128 v[60:63], v8 offset:8192
    ds_read_b64_tr_b16 v[64:65], v11 offset:4096
    ds_read_b64_tr_b16 v[66:67], v11 offset:6144
G3_L1:
    ds_read_b128 v[68:71], v9 offset:0
    s_waitcnt lgkmcnt(7)
    v_mfma_f32_16x16x32_bf16 v[16:19], v[40:43], v[44:47], v[16:19]
    s_add_u32 s51, s51, 1
    s_cmp_eq_u32 s51, 8
    s_cselect_b32 s61, 4294838272, s53
    s_cselect_b32 s51, 0, s51
    ds_read_b128 v[72:75], v9 offset:2048
    s_waitcnt lgkmcnt(7)
    v_mfma_f32_16x16x32_bf16 v[20:23], v[40:43], v[48:51], v[20:23]
    v_add_u32 v11, s61, v11
    ds_read_b128 v[76:79], v9 offset:4096
    s_waitcnt lgkmcnt(7)
    v_mfma_f32_16x16x32_bf16 v[24:27], v[40:43], v[52:55], v[24:27]
    v_add_u32 v8, s61, v8
    v_add_u32 v10, s61, v10
    ds_read_b128 v[80:83], v9 offset:6144
    s_waitcnt lgkmcnt(7)
    v_mfma_f32_16x16x32_bf16 v[28:31], v[40:43], v[56:59], v[28:31]
    ds_read_b128 v[84:87], v9 offset:8192
    s_waitcnt lgkmcnt(7)
    v_mfma_f32_16x16x32_bf16 v[32:35], v[40:43], v[60:63], v[32:35]
    v_add_u32 v9, s61, v9
    s_barrier
    ds_read_b64_tr_b16 v[40:41], v11 offset:0
    ds_read_b64_tr_b16 v[42:43], v11 offset:2048
    ds_read_b128 v[44:47], v8 offset:0
    s_waitcnt lgkmcnt(7)
    v_mfma_f32_16x16x32_bf16 v[16:19], v[64:67], v[68:71], v[16:19]
    ds_read_b128 v[48:51], v8 offset:2048
    s_waitcnt lgkmcnt(7)
    v_mfma_f32_16x16x32_bf16 v[20:23], v[64:67], v[72:75], v[20:23]
    ds_read_b128 v[52:55], v8 offset:4096
    s_waitcnt lgkmcnt(7)
    v_mfma_f32_16x16x32_bf16 v[24:27], v[64:67], v[76:79], v[24:27]
    ds_read_b128 v[56:59], v8 offset:6144
    s_waitcnt lgkmcnt(7)
    v_mfma_f32_16x16x32_bf16 v[28:31], v[64:67], v[80:83], v[28:31]
    ds_read_b128 v[60:63], v8 offset:8192
    s_waitcnt lgkmcnt(7)
    v_mfma_f32_16x16x32_bf16 v[32:35], v[64:67], v[84:87], v[32:35]
    ds_read_b64_tr_b16 v[64:65], v11 offset:4096
    ds_read_b64_tr_b16 v[66:67], v11 offset:6144
    s_sub_u32 s52, s52, 1
    s_cmp_lg_u32 s52, 0
    s_cbranch_scc1 G3_L1
    ds_read_b128 v[68:71], v9 offset:0
    s_waitcnt lgkmcnt(7)
    v_mfma_f32_16x16x32_bf16 v[16:19], v[40:43], v[44:47], v[16:19]
    s_add_u32 s51, s51, 1
    s_cmp_eq_u32 s51, 8
    s_cselect_b32 s61, 4294838272, s53
    s_cselect_b32 s51, 0, s51
    ds_read_b128 v[72:75], v9 offset:2048
    s_waitcnt lgkmcnt(7)
    v_mfma_f32_16x16x32_bf16 v[20:23], v[40:43], v[48:51], v[20:23]
    v_add_u32 v11, s61, v11
    ds_read_b128 v[76:79], v9 offset:4096
    s_waitcnt lgkmcnt(7)
    v_mfma_f32_16x16x32_bf16 v[24:27], v[40:43], v[52:55], v[24:27]
    v_add_u32 v8, s61, v8
    v_add_u32 v10, s61, v10
    ds_read_b128 v[80:83], v9 offset:6144
    s_waitcnt lgkmcnt(7)
    v_mfma_f32_16x16x32_bf16 v[28:31], v[40:43], v[56:59], v[28:31]
    ds_read_b128 v[84:87], v9 offset:8192
    s_waitcnt lgkmcnt(7)
    v_mfma_f32_16x16x32_bf16 v[32:35], v[40:43], v[60:63], v[32:35]
    v_add_u32 v9, s61, v9
    s_barrier
    ds_read_b64_tr_b16 v[40:41], v11 offset:0
    ds_read_b64_tr_b16 v[42:43], v11 offset:2048
    ds_read_b64_tr_b16 v[44:45], v10 offset:0
    ds_read_b64_tr_b16 v[46:47], v10 offset:2560
    s_waitcnt lgkmcnt(8)
    v_mfma_f32_16x16x32_bf16 v[16:19], v[64:67], v[68:71], v[16:19]
    ds_read_b64_tr_b16 v[48:49], v10 offset:512
    ds_read_b64_tr_b16 v[50:51], v10 offset:3072
    s_waitcnt lgkmcnt(9)
    v_mfma_f32_16x16x32_bf16 v[20:23], v[64:67], v[72:75], v[20:23]
    ds_read_b64_tr_b16 v[52:53], v10 offset:1024
    ds_read_b64_tr_b16 v[54:55], v10 offset:3584
    s_waitcnt lgkmcnt(10)
    v_mfma_f32_16x16x32_bf16 v[24:27], v[64:67], v[76:79], v[24:27]
    ds_read_b64_tr_b16 v[56:57], v10 offset:1536
    ds_read_b64_tr_b16 v[58:59], v10 offset:4096
    s_waitcnt lgkmcnt(11)
    v_mfma_f32_16x16x32_bf16 v[28:31], v[64:67], v[80:83], v[28:31]
    ds_read_b64_tr_b16 v[60:61], v10 offset:2048
    ds_read_b64_tr_b16 v[62:63], v10 offset:4608
    s_waitcnt lgkmcnt(12)
    v_mfma_f32_16x16x32_bf16 v[32:35], v[64:67], v[84:87], v[32:35]
    ds_read_b64_tr_b16 v[64:65], v11 offset:4096
    ds_read_b64_tr_b16 v[66:67], v11 offset:6144
    s_mov_b32 s52, 36
G3_L2:
    ds_read_b64_tr_b16 v[68:69], v10 offset:5120
    ds_read_b64_tr_b16 v[70:71], v10 offset:7680
    s_waitcnt lgkmcnt(12)
    v_mfma_f32_16x16x32_bf16 v[16:19], v[40:43], v[44:47], v[16:19]
    s_add_u32 s51, s51, 1
    s_cmp_eq_u32 s51, 8
    s_cselect_b32 s61, 4294838272, s53
    s_cselect_b32 s51, 0, s51
    ds_read_b64_tr_b16 v[72:73], v10 offset:5632
    ds_read_b64_tr_b16 v[74:75], v10 offset:8192
    s_waitcnt lgkmcnt(12)
    v_mfma_f32_16x16x32_bf16 v[20:23], v[40:43], v[48:51], v[20:23]
    v_add_u32 v11, s61, v11
    ds_read_b64_tr_b16 v[76:77], v10 offset:6144
    ds_read_b64_tr_b16 v[78:79], v10 offset:8704
    s_waitcnt lgkmcnt(12)
    v_mfma_f32_16x16x32_bf16 v[24:27], v[40:43], v[52:55], v[24:27]
    ds_read_b64_tr_b16 v[80:81], v10 offset:6656
    ds_read_b64_tr_b16 v[82:83], v10 offset:9216
    s_waitcnt lgkmcnt(12)
    v_mfma_f32_16x16x32_bf16 v[28:31], v[40:43], v[56:59], v[28:31]
    ds_read_b64_tr_b16 v[84:85], v10 offset:7168
    ds_read_b64_tr_b16 v[86:87], v10 offset:9728
    s_waitcnt lgkmcnt(12)
    v_mfma_f32_16x16x32_bf16 v[32:35], v[40:43], v[60:63], v[32:35]
    v_add_u32 v10, s61, v10
    s_barrier
    ds_read_b64_tr_b16 v[40:41], v11 offset:0
    ds_read_b64_tr_b16 v[42:43], v11 offset:2048
    ds_read_b64_tr_b16 v[44:45], v10 offset:0
    ds_read_b64_tr_b16 v[46:47], v10 offset:2560
    s_waitcnt lgkmcnt(12)
    v_mfma_f32_16x16x32_bf16 v[16:19], v[64:67], v[68:71], v[16:19]
    ds_read_b64_tr_b16 v[48:49], v10 offset:512
    ds_read_b64_tr_b16 v[50:51], v10 offset:3072
    s_waitcnt lgkmcnt(12)
    v_mfma_f32_16x16x32_bf16 v[20:23], v[64:67], v[72:75], v[20:23]
    ds_read_b64_tr_b16 v[52:53], v10 offset:1024
    ds_read_b64_tr_b16 v[54:55], v10 offset:3584
    s_waitcnt lgkmcnt(12)
    v_mfma_f32_16x16x32_bf16 v[24:27], v[64:67], v[76:79], v[24:27]
    ds_read_b64_tr_b16 v[56:57], v10 offset:1536
    ds_read_b64_tr_b16 v[58:59], v10 offset:4096
    s_waitcnt lgkmcnt(12)
    v_mfma_f32_16x16x32_bf16 v[28:31], v[64:67], v[80:83], v[28:31]
    ds_read_b64_tr_b16 v[60:61], v10 offset:2048
    ds_read_b64_tr_b16 v[62:63], v10 offset:4608
    s_waitcnt lgkmcnt(12)
    v_mfma_f32_16x16x32_bf16 v[32:35], v[64:67], v[84:87], v[32:35]
    ds_read_b64_tr_b16 v[64:65], v11 offset:4096
    ds_read_b64_tr_b16 v[66:67], v11 offset:6144
    s_sub_u32 s52, s52, 1
    s_cmp_lg_u32 s52, 0
    s_cbranch_scc1 G3_L2
    s_waitcnt lgkmcnt(0)
    s_lshl_b32 s3, s44, 4
    v_add_u32 v3, s3, v1
    v_mul_u32_u24 v3, 1152, v3
    v_and_b32 v2, 1, v4
    v_mul_u32_u24 v2, 18432, v2
    v_add_u32 v2, v2, v3
    v_lshrrev_b32 v7, 1, v4
    v_lshl_add_u32 v2, v7, 4, v2
    v_lshl_add_u32 v3, v4, 3, v3
    s_lshl_b32 s3, s45, 7
    s_lshl_b32 s4, s47, 5
    s_add_u32 s3, s3, s4
    s_add_u32 s4, s3, 36864
    s_add_u32 s5, s3, 73728
    v_cvt_pk_bf16_f32 v40, v16, v17
    v_cvt_pk_bf16_f32 v41, v18, v19
    v_cvt_pk_bf16_f32 v42, v20, v21
    v_cvt_pk_bf16_f32 v43, v22, v23
    s_nop 0
    v_permlane16_swap_b32 v40, v42
    v_permlane16_swap_b32 v41, v43
    buffer_store_dwordx4 v[40:43], v2, s[24:27], s3 offen
    v_cvt_pk_bf16_f32 v44, v24, v25
    v_cvt_pk_bf16_f32 v45, v26, v27
    v_cvt_pk_bf16_f32 v46, v28, v29
    v_cvt_pk_bf16_f32 v47, v30, v31
    s_nop 0
    v_permlane16_swap_b32 v44, v46
    v_permlane16_swap_b32 v45, v47
    buffer_store_dwordx4 v[44:47], v2, s[24:27], s4 offen
    v_cvt_pk_bf16_f32 v48, v32, v33
    v_cvt_pk_bf16_f32 v49, v34, v35
    buffer_store_dwordx2 v[48:49], v3, s[24:27], s5 offen
    s_endpgm
GF_OGR:
    s_sleep 4
    buffer_load_dwordx4 v[60:63], v137, s[36:39], s65 offen offset:0 sc1
    buffer_load_dwordx4 v[64:67], v137, s[36:39], s65 offen offset:16 sc1
    buffer_load_dwordx4 v[68:71], v137, s[36:39], s65 offen offset:32 sc1
    buffer_load_dwordx4 v[72:75], v137, s[36:39], s65 offen offset:48 sc1
    s_add_u32 s62, s62, 1
    s_waitcnt vmcnt(0)
    s_cmp_lt_u32 s62, 0x8000
    s_cbranch_scc1 GF_OGC
    s_branch GF_OGK
GF_GSPIN0:
    s_sleep 1
    ds_read_b32 v83, v82
    s_waitcnt lgkmcnt(0)
    v_cmp_gt_u32 vcc, s63, v83
    s_nop 1
    s_cbranch_vccnz GF_GSPIN0
    s_branch GF_GBACK0
GF_GSPIN1:
    s_sleep 1
    ds_read_b32 v83, v82
    s_waitcnt lgkmcnt(0)
    v_cmp_gt_u32 vcc, s63, v83
    s_nop 1
    s_cbranch_vccnz GF_GSPIN1
    s_branch GF_GBACK1
GF_GSPIN2:
    s_sleep 1
    ds_read_b32 v83, v82
    s_waitcnt lgkmcnt(0)
    v_cmp_gt_u32 vcc, s63, v83
    s_nop 1
    s_cbranch_vccnz GF_GSPIN2
    s_branch GF_GBACK2
GF_GSPIN3:
    s_sleep 1
    ds_read_b32 v83, v82
    s_waitcnt lgkmcnt(0)
    v_cmp_gt_u32 vcc, s63, v83
    s_nop 1
    s_cbranch_vccnz GF_GSPIN3
    s_branch GF_GBACK3
GF_GON3:
    s_lshl_b32 s5, s52, 1
    s_add_u32 s5, s5, 3
    s_setprio 3
    s_cmp_lg_u32 s48, 0
    s_cbranch_scc1 GF_ZCED
    s_mov_b32 s62, 0
GF_ZCE:
    v_cmp_ne_u32 vcc, v132, v135
    v_cmp_ge_u32 s[50:51], s5, v134
    s_nop 0
    s_cmp_eq_u64 vcc, 0
    s_cselect_b32 s48, 1, 0
    s_cbranch_scc1 GF_ZCED
    buffer_load_dword v135, v133, s[36:39], s4 offen sc1
    s_and_b64 s[50:51], vcc, s[50:51]
    s_cbranch_scc0 GF_ZCED
    s_add_u32 s62, s62, 1
    s_waitcnt vmcnt(0)
    s_cmp_lt_u32 s62, 0x40000
    s_cbranch_scc1 GF_ZCE
GF_ZCED:
    s_setprio 0
    s_branch GF_GON3B
GF_GONCE:
    s_lshl_b32 s5, s52, 1
    s_add_u32 s5, s5, 2
    s_setprio 3
    s_cmp_lg_u32 s48, 0
    s_cbranch_scc1 GF_ZCBD
    s_mov_b32 s62, 0
GF_ZCB:
    v_cmp_ne_u32 vcc, v132, v135
    v_cmp_ge_u32 s[50:51], s5, v134
    s_nop 0
    s_cmp_eq_u64 vcc, 0
    s_cselect_b32 s48, 1, 0
    s_cbranch_scc1 GF_ZCBD
    buffer_load_dword v135, v133, s[36:39], s4 offen sc1
    s_and_b64 s[50:51], vcc, s[50:51]
    s_cbranch_scc0 GF_ZCBD
    s_add_u32 s62, s62, 1
    s_waitcnt vmcnt(0)
    s_cmp_lt_u32 s62, 0x40000
    s_cbranch_scc1 GF_ZCB
GF_ZCBD:
    s_setprio 0
    s_cmp_eq_u32 s52, 7
    s_cbranch_scc1 GF_GO29
    s_mov_b32 s5, 3
    s_cmp_lg_u32 s52, s5
    s_cbranch_scc1 GF_GONCEB
    s_lshl_b32 s5, s2, 2
    s_add_u32 s5, s5, s47
    s_lshl_b32 s5, s5, 13
    buffer_load_dword v125, v138, s[12:15], s5 offen
    s_sub_u32 s5, 8380416, s5
    buffer_load_dword v125, v138, s[16:19], s5 offen
    s_branch GF_GONCEB
GF_GO29:
    buffer_load_dwordx4 v[168:171], v136, s[32:35], s7 offen
    buffer_load_dwordx4 v[60:63], v137, s[36:39], s65 offen offset:0 sc1
    buffer_load_dwordx4 v[64:67], v137, s[36:39], s65 offen offset:16 sc1
    buffer_load_dwordx4 v[68:71], v137, s[36:39], s65 offen offset:32 sc1
    buffer_load_dwordx4 v[72:75], v137, s[36:39], s65 offen offset:48 sc1
    s_mov_b32 s26, 0
    s_mov_b32 s30, 0
    s_branch GF_GONCEB
GF_LOADER:
    s_mov_b32 s66, s47
    s_sub_u32 s47, s47, 4
    v_lshrrev_b32 v1, 3, v0
    v_and_b32 v2, 7, v0
    v_lshrrev_b32 v3, 1, v1
    v_xor_b32 v2, v2, v3
    v_lshrrev_b32 v3, 2, v1
    v_and_b32 v1, 3, v1
    v_lshl_add_u32 v1, v3, 3, v1
    s_lshl_b32 s3, s44, 7
    s_lshl_b32 s4, s47, 5
    s_add_u32 s3, s3, s4
    v_add_u32 v1, s3, v1
    v_mul_u32_u24 v1, 1152, v1
    v_lshlrev_b32 v2, 4, v2
    v_add_u32 v8, v1, v2
    v_xor_b32 v2, 64, v2
    v_add_u32 v9, v1, v2
    v_add_u32 v9, 18432, v9
    s_add_u32 s3, s44, s45
    s_and_b32 s3, s3, 1
    s_mul_i32 s3, s3, 9
    s_lshr_b32 s3, s3, 1
    s_lshr_b32 s4, s44, 3
    s_mul_i32 s4, s4, 2
    s_add_u32 s54, s3, s4
    s_lshl_b32 s51, s54, 7
    s_lshl_b32 s54, s54, 1
    s_lshl_b32 s56, s47, 12
    s_mov_b32 m0, s56
    s_mul_i32 s52, s54, 294912
    buffer_load_dwordx4 v8, s[24:27], s51 offen lds
    s_add_u32 m0, m0, 1024
    s_add_u32 s3, s51, 4608
    buffer_load_dwordx4 v9, s[24:27], s51 offen lds
    s_add_u32 m0, m0, 1024
    s_add_u32 s51, s51, 128
    buffer_load_dwordx4 v8, s[24:27], s3 offen lds
    s_add_u32 m0, m0, 1024
    s_mul_i32 s5, s45, 288
    buffer_load_dwordx4 v9, s[24:27], s3 offen lds
    s_cmp_eq_u32 s51, 1152
    s_cselect_b32 s51, 0, s51
    s_add_u32 s56, s56, 16384
    s_mov_b32 s48, 0
    s_and_b32 s7, s45, 1
    s_lshl_b32 s60, s7, 5
    s_add_u32 s60, s60, s5
    s_cmp_eq_u32 s7, 0
    s_cselect_b32 s61, 256, 0
    s_add_u32 s61, s61, s5
    s_movk_i32 s6, 1821
    s_lshl_b32 s57, s47, 12
    s_add_u32 s57, s57, 49152
    s_and_b32 s58, s47, 1
    s_lshl_b32 s58, s58, 10
    s_add_u32 s58, s58, 65536
    s_lshl_b32 s59, s47, 10
    s_add_u32 s59, s59, 67584
    s_lshl_b32 s3, s47, 8
    s_add_u32 s3, s3, 0
    s_add_u32 m0, s57, 0
    v_add_u32 v1, s3, v0
    v_mul_u32_u24 v2, s6, v1
    v_lshrrev_b32 v2, 16, v2
    v_mul_u32_u24 v3, 36, v2
    v_sub_u32 v3, v1, v3
    v_lshrrev_b32 v4, 2, v2
    v_and_b32 v4, 2, v4
    v_xor_b32 v3, v3, v4
    v_mul_u32_u24 v2, 9216, v2
    v_and_b32 v4, 15, v3
    v_lshlrev_b32 v4, 4, v4
    v_add_u32 v4, s60, v4
    v_bfe_u32 v5, v3, 4, 1
    v_and_b32 v6, 1, v3
    v_lshlrev_b32 v6, 4, v6
    v_add_u32 v6, s61, v6
    v_bfe_u32 v7, v3, 1, 1
    v_cmp_gt_u32 vcc, 32, v3
    s_nop 1
    v_cndmask_b32 v4, v6, v4, vcc
    v_cndmask_b32 v5, v7, v5, vcc
    v_mul_u32_u24 v5, 4608, v5
    v_add3_u32 v10, v2, v4, v5
    buffer_load_dwordx4 v10, s[28:31], s52 offen lds
    s_lshl_b32 s3, s47, 8
    s_add_u32 s3, s3, 64
    s_add_u32 m0, s57, 1024
    v_add_u32 v1, s3, v0
    v_mul_u32_u24 v2, s6, v1
    v_lshrrev_b32 v2, 16, v2
    v_mul_u32_u24 v3, 36, v2
    v_sub_u32 v3, v1, v3
    v_lshrrev_b32 v4, 2, v2
    v_and_b32 v4, 2, v4
    v_xor_b32 v3, v3, v4
    v_mul_u32_u24 v2, 9216, v2
    v_and_b32 v4, 15, v3
    v_lshlrev_b32 v4, 4, v4
    v_add_u32 v4, s60, v4
    v_bfe_u32 v5, v3, 4, 1
    v_and_b32 v6, 1, v3
    v_lshlrev_b32 v6, 4, v6
    v_add_u32 v6, s61, v6
    v_bfe_u32 v7, v3, 1, 1
    v_cmp_gt_u32 vcc, 32, v3
    s_nop 1
    v_cndmask_b32 v4, v6, v4, vcc
    v_cndmask_b32 v5, v7, v5, vcc
    v_mul_u32_u24 v5, 4608, v5
    v_add3_u32 v11, v2, v4, v5
    buffer_load_dwordx4 v11, s[28:31], s52 offen lds
    s_lshl_b32 s3, s47, 8
    s_add_u32 s3, s3, 128
    s_add_u32 m0, s57, 2048
    v_add_u32 v1, s3, v0
    v_mul_u32_u24 v2, s6, v1
    v_lshrrev_b32 v2, 16, v2
    v_mul_u32_u24 v3, 36, v2
    v_sub_u32 v3, v1, v3
    v_lshrrev_b32 v4, 2, v2
    v_and_b32 v4, 2, v4
    v_xor_b32 v3, v3, v4
    v_mul_u32_u24 v2, 9216, v2
    v_and_b32 v4, 15, v3
    v_lshlrev_b32 v4, 4, v4
    v_add_u32 v4, s60, v4
    v_bfe_u32 v5, v3, 4, 1
    v_and_b32 v6, 1, v3
    v_lshlrev_b32 v6, 4, v6
    v_add_u32 v6, s61, v6
    v_bfe_u32 v7, v3, 1, 1
    v_cmp_gt_u32 vcc, 32, v3
    s_nop 1
    v_cndmask_b32 v4, v6, v4, vcc
    v_cndmask_b32 v5, v7, v5, vcc
    v_mul_u32_u24 v5, 4608, v5
    v_add3_u32 v12, v2, v4, v5
    buffer_load_dwordx4 v12, s[28:31], s52 offen lds
    s_lshl_b32 s3, s47, 8
    s_add_u32 s3, s3, 192
    s_add_u32 m0, s57, 3072
    v_add_u32 v1, s3, v0
    v_mul_u32_u24 v2, s6, v1
    v_lshrrev_b32 v2, 16, v2
    v_mul_u32_u24 v3, 36, v2
    v_sub_u32 v3, v1, v3
    v_lshrrev_b32 v4, 2, v2
    v_and_b32 v4, 2, v4
    v_xor_b32 v3, v3, v4
    v_mul_u32_u24 v2, 9216, v2
    v_and_b32 v4, 15, v3
    v_lshlrev_b32 v4, 4, v4
    v_add_u32 v4, s60, v4
    v_bfe_u32 v5, v3, 4, 1
    v_and_b32 v6, 1, v3
    v_lshlrev_b32 v6, 4, v6
    v_add_u32 v6, s61, v6
    v_bfe_u32 v7, v3, 1, 1
    v_cmp_gt_u32 vcc, 32, v3
    s_nop 1
    v_cndmask_b32 v4, v6, v4, vcc
    v_cndmask_b32 v5, v7, v5, vcc
    v_mul_u32_u24 v5, 4608, v5
    v_add3_u32 v13, v2, v4, v5
    buffer_load_dwordx4 v13, s[28:31], s52 offen lds
    s_and_b32 s3, s47, 1
    s_lshl_b32 s3, s3, 6
    s_add_u32 s3, s3, 1024
    s_mov_b32 m0, s58
    v_add_u32 v1, s3, v0
    v_mul_u32_u24 v2, s6, v1
    v_lshrrev_b32 v2, 16, v2
    v_mul_u32_u24 v3, 36, v2
    v_sub_u32 v3, v1, v3
    v_lshrrev_b32 v4, 2, v2
    v_and_b32 v4, 2, v4
    v_xor_b32 v3, v3, v4
    v_mul_u32_u24 v2, 9216, v2
    v_and_b32 v4, 15, v3
    v_lshlrev_b32 v4, 4, v4
    v_add_u32 v4, s60, v4
    v_bfe_u32 v5, v3, 4, 1
    v_and_b32 v6, 1, v3
    v_lshlrev_b32 v6, 4, v6
    v_add_u32 v6, s61, v6
    v_bfe_u32 v7, v3, 1, 1
    v_cmp_gt_u32 vcc, 32, v3
    s_nop 1
    v_cndmask_b32 v4, v6, v4, vcc
    v_cndmask_b32 v5, v7, v5, vcc
    v_mul_u32_u24 v5, 4608, v5
    v_add3_u32 v14, v2, v4, v5
    buffer_load_dwordx4 v14, s[28:31], s52 offen lds
    s_mov_b32 s40, s92
    s_mov_b32 s41, s93
    s_mov_b32 s42, 256
    s_lshl_b32 s3, s47, 12
    v_mov_b32 v20, s3
    s_load_dwordx2 s[8:9], s[0:1], 56
    v_lshlrev_b32 v22, 7, v0
    s_lshl_b32 s49, s2, 2
    s_add_u32 s49, s49, s47
    s_lshl_b32 s49, s49, 13
    s_mul_i32 s63, s47, 3
    s_add_u32 s63, s63, 0
    s_mov_b32 s50, 0
    s_mov_b32 m0, s59
    s_cmp_ge_u32 s46, 12
    s_cbranch_scc1 GF_LOADER_KV
    s_lshl_b32 s3, s47, 3
    v_lshrrev_b32 v1, 3, v0
    v_add_u32 v1, s3, v1
    v_bfe_u32 v2, v1, 1, 1
    v_bfe_u32 v3, v1, 3, 1
    v_lshl_or_b32 v2, v3, 1, v2
    v_lshlrev_b32 v2, 1, v2
    v_and_b32 v3, 7, v0
    v_xor_b32 v3, v3, v2
    v_mul_u32_u24 v1, 1152, v1
    v_lshl_add_u32 v1, v3, 4, v1
    s_mul_i32 s3, s46, 96
    s_andn2_b32 s3, s3, 63
    v_add_u32 v16, s3, v1
    s_mul_i32 s53, s54, 36864
    buffer_load_dwordx4 v16, s[32:35], s53 offen lds
    s_add_u32 s54, s54, 1
    s_cmp_eq_u32 s54, 18
    s_cselect_b32 s54, 0, s54
    s_mul_i32 s52, s54, 294912
    s_mul_i32 s53, s54, 36864
    s_add_u32 s50, s50, 22528
    s_cmp_eq_u32 s50, 112640
    s_cselect_b32 s50, 0, s50
    s_mov_b32 s55, 0
    s_waitcnt lgkmcnt(0)
    s_mov_b32 s10, 8388608
    s_mov_b32 s11, 0x00020000
GF_LM_1:
    s_mov_b32 m0, s56
    s_add_u32 s3, s51, s48
    buffer_load_dwordx4 v8, s[24:27], s3 offen lds
    s_add_u32 m0, m0, 1024
    s_xor_b32 s48, s48, 4608
    buffer_load_dwordx4 v9, s[24:27], s3 offen lds
    s_cselect_b32 s3, 0, 128
    s_cselect_b32 s4, 0, 12288
    s_add_u32 s51, s51, s3
    s_add_u32 s56, s56, s4
    s_add_u32 s56, s56, 2048
    s_cmp_eq_u32 s51, 1152
    s_cselect_b32 s51, 0, s51
    s_cmp_ge_u32 s56, 49152
    s_cselect_b32 s3, 49152, 0
    s_sub_u32 s56, s56, s3
    s_add_u32 m0, s50, s57
    s_nop 0
    buffer_load_dwordx4 v10, s[28:31], s52 offen lds
    s_add_u32 m0, m0, 1024
    s_nop 0
    buffer_load_dwordx4 v11, s[28:31], s52 offen lds
    s_add_u32 m0, m0, 1024
    s_nop 0
    buffer_load_dwordx4 v12, s[28:31], s52 offen lds
    s_add_u32 m0, m0, 1024
    s_nop 0
    buffer_load_dwordx4 v13, s[28:31], s52 offen lds
    s_add_u32 m0, s50, s58
    s_nop 0
    buffer_load_dwordx4 v14, s[28:31], s52 offen lds
    s_add_u32 m0, s50, s59
    s_nop 0
    buffer_load_dwordx4 v16, s[32:35], s53 offen lds
    s_add_u32 s54, s54, 1
    s_cmp_eq_u32 s54, 18
    s_cselect_b32 s54, 0, s54
    s_mul_i32 s52, s54, 294912
    s_mul_i32 s53, s54, 36864
    s_add_u32 s50, s50, 22528
    s_cmp_eq_u32 s50, 112640
    s_cselect_b32 s50, 0, s50
    s_add_u32 s55, s55, 1
    s_cmp_eq_u32 s55, 2
    s_cbranch_scc1 GF_LM_1
    s_cmp_eq_u32 s55, 17
    s_cbranch_scc1 GF_LT_3
    s_cmp_lg_u32 s55, 1
    s_cbranch_scc1 GF_LS_2
    s_waitcnt vmcnt(8)
GF_LS_2:
    s_waitcnt vmcnt(16)
    s_barrier
    s_branch GF_LM_1
GF_LT_3:
    buffer_load_dword v21, v20, s[40:43], 0 offen sc1
    s_waitcnt vmcnt(17)
    s_barrier
    s_waitcnt vmcnt(9)
    s_barrier
    s_waitcnt vmcnt(1)
    s_barrier
    s_branch GF_PF
GF_LOADER_KV:
    s_lshl_b32 s3, s47, 3
    v_lshrrev_b32 v1, 4, v0
    v_add_u32 v1, s3, v1
    v_and_b32 v3, 15, v0
    v_mul_u32_u24 v1, 36, v1
    v_lshl_add_u32 v1, v3, 2, v1
    v_mov_b32 v2, 0x40000000
    v_cmp_gt_u32 vcc, 9, v3
    s_nop 1
    v_cndmask_b32 v16, v2, v1, vcc
    v_add_u32 v17, 144, v16
    s_mul_i32 s53, s54, 1152
    buffer_load_dword v16, s[32:35], s53 offen lds
    s_add_u32 m0, m0, 512
    s_nop 0
    buffer_load_dword v17, s[32:35], s53 offen lds
    s_add_u32 s54, s54, 1
    s_cmp_eq_u32 s54, 18
    s_cselect_b32 s54, 0, s54
    s_mul_i32 s52, s54, 294912
    s_mul_i32 s53, s54, 1152
    s_add_u32 s50, s50, 22528
    s_cmp_eq_u32 s50, 112640
    s_cselect_b32 s50, 0, s50
    s_mov_b32 s55, 0
    s_waitcnt lgkmcnt(0)
    s_mov_b32 s10, 8388608
    s_mov_b32 s11, 0x00020000
GF_LM_4:
    s_mov_b32 m0, s56
    s_add_u32 s3, s51, s48
    buffer_load_dwordx4 v8, s[24:27], s3 offen lds
    s_add_u32 m0, m0, 1024
    s_xor_b32 s48, s48, 4608
    buffer_load_dwordx4 v9, s[24:27], s3 offen lds
    s_cselect_b32 s3, 0, 128
    s_cselect_b32 s4, 0, 12288
    s_add_u32 s51, s51, s3
    s_add_u32 s56, s56, s4
    s_add_u32 s56, s56, 2048
    s_cmp_eq_u32 s51, 1152
    s_cselect_b32 s51, 0, s51
    s_cmp_ge_u32 s56, 49152
    s_cselect_b32 s3, 49152, 0
    s_sub_u32 s56, s56, s3
    s_add_u32 m0, s50, s57
    s_nop 0
    buffer_load_dwordx4 v10, s[28:31], s52 offen lds
    s_add_u32 m0, m0, 1024
    s_nop 0
    buffer_load_dwordx4 v11, s[28:31], s52 offen lds
    s_add_u32 m0, m0, 1024
    s_nop 0
    buffer_load_dwordx4 v12, s[28:31], s52 offen lds
    s_add_u32 m0, m0, 1024
    s_nop 0
    buffer_load_dwordx4 v13, s[28:31], s52 offen lds
    s_add_u32 m0, s50, s58
    s_nop 0
    buffer_load_dwordx4 v14, s[28:31], s52 offen lds
    s_add_u32 m0, s50, s59
    s_nop 0
    buffer_load_dword v16, s[32:35], s53 offen lds
    s_add_u32 m0, m0, 512
    s_nop 0
    buffer_load_dword v17, s[32:35], s53 offen lds
    s_add_u32 s54, s54, 1
    s_cmp_eq_u32 s54, 18
    s_cselect_b32 s54, 0, s54
    s_mul_i32 s52, s54, 294912
    s_mul_i32 s53, s54, 1152
    s_add_u32 s50, s50, 22528
    s_cmp_eq_u32 s50, 112640
    s_cselect_b32 s50, 0, s50
    s_add_u32 s55, s55, 1
    s_cmp_eq_u32 s55, 2
    s_cbranch_scc1 GF_LM_4
    s_cmp_eq_u32 s55, 17
    s_cbranch_scc1 GF_LT_6
    s_cmp_lg_u32 s55, 1
    s_cbranch_scc1 GF_LS_5
    s_waitcnt vmcnt(9)
GF_LS_5:
    s_waitcnt vmcnt(18)
    s_barrier
    s_branch GF_LM_4
GF_LT_6:
    buffer_load_dword v21, v20, s[40:43], 0 offen sc1
    s_waitcnt vmcnt(19)
    s_barrier
    s_waitcnt vmcnt(10)
    s_barrier
    s_waitcnt vmcnt(1)
    s_barrier
GF_PF:
    s_mov_b32 s62, 0
    s_cmp_lg_u32 s47, 0
    s_cbranch_scc1 GF_TAGSKIP
GF_TAGWAIT:
    s_waitcnt vmcnt(0)
    v_readfirstlane_b32 s4, v21
    s_add_u32 s62, s62, 1
    s_nop 0
    s_cmp_lg_u32 s4, 0
    s_cbranch_scc1 GF_TAGOK
    s_sleep 4
    buffer_load_dword v21, v20, s[40:43], 0 offen sc1
    s_cmp_lt_u32 s62, 0x8000
    s_cbranch_scc1 GF_TAGWAIT
GF_TAGOK:
    v_mov_b32 v24, 161792
    s_mov_b64 exec, 1
    ds_write_b32 v24, v21
    s_mov_b64 exec, -1
GF_TAGSKIP:
    s_waitcnt lgkmcnt(0)
    s_barrier
    s_setprio 3
    v_mov_b32 v15, 161792
    ds_read_b32 v15, v15
    s_lshl_b32 s5, s66, 8
    s_add_u32 s5, s5, 39936
    s_cmp_ge_u32 s66, 4
    s_cselect_b32 s6, 39936, 0
    s_add_u32 s5, s5, s6
    v_lshl_add_u32 v84, v0, 2, s5
    v_mov_b32 v85, 0
    v_mov_b32 v82, 0
    s_waitcnt lgkmcnt(0)
    s_barrier
    ds_write_b32 v84, v82
    v_lshlrev_b32 v83, 2, v0
    v_add_u32 v83, 162816, v83
    ds_write_b32 v83, v85
    s_waitcnt lgkmcnt(0)
    v_mov_b32 v85, 1
    s_barrier
    s_mov_b32 s24, s8
    s_mov_b32 s25, s9
    s_mov_b32 s26, 8388608
    s_mov_b32 s27, 0x00020000
    s_mul_i32 s5, s47, 7168
    s_add_u32 s5, s5, 81920
    v_lshl_add_u32 v1, v0, 4, s5
    ds_read_b64 v[86:87], v1 offset:6144
    ds_read_b128 v[232:235], v1
    ds_read_b128 v[236:239], v1 offset:1024
    ds_read_b128 v[240:243], v1 offset:2048
    ds_read_b128 v[244:247], v1 offset:3072
    ds_read_b128 v[248:251], v1 offset:4096
    ds_read_b128 v[252:255], v1 offset:5120
    s_lshl_b32 s3, s44, 2
    s_add_u32 s3, s3, s47
    s_lshl_b32 s5, s3, 5
    s_lshl_b32 s4, s45, 1
    s_add_u32 s5, s5, s4
    v_lshrrev_b32 v81, 5, v0
    v_add_u32 v81, s5, v81
    v_lshlrev_b32 v81, 3, v81
    v_lshrrev_b32 v4, 4, v0
    s_waitcnt lgkmcnt(0)
    v_mov_b32 v32, v86
    v_mov_b32 v33, v15
    v_mov_b32 v34, v87
    v_mov_b32 v35, v15
    s_mov_b32 s4, 41177088
    s_mov_b32 s5, 41193472
    s_mov_b32 exec_lo, 1
    s_mov_b32 exec_hi, 1
    buffer_store_dwordx2 v[32:33], v81, s[36:39], s4 offen sc1
    buffer_store_dwordx2 v[34:35], v81, s[36:39], s5 offen sc1
    s_mov_b64 exec, -1
    s_lshl_b32 s64, s3, 6
    s_lshl_b32 s4, s45, 2
    s_add_u32 s64, s64, s4
    s_add_u32 s64, s64, 41160704
    s_mov_b32 s65, 1
    v_lshlrev_b32 v80, 9, v0
    s_cmp_ge_u32 s45, 14
    s_cbranch_scc1 GF_EDONE
    v_and_b32 v5, 15, v0
    v_lshrrev_b32 v6, 2, v5
    v_lshlrev_b32 v6, 3, v6
    v_and_b32 v7, 3, v5
    v_add_u32 v6, v6, v7
    v_and_b32 v7, 1, v4
    v_lshl_add_u32 v7, v7, 2, v6
    v_lshrrev_b32 v2, 1, v4
    s_add_u32 s5, s3, 1
    s_lshr_b32 s6, s5, 1
    s_and_b32 s7, s5, 1
    s_mul_i32 s6, s6, 4608
    s_add_u32 s6, s6, 4718592
    s_cmp_eq_u32 s46, 12
    s_cbranch_scc1 GF_EK
    s_cmp_eq_u32 s46, 13
    s_cbranch_scc1 GF_EV
    s_lshl_b32 s4, s3, 5
    v_add_u32 v7, s4, v7
    v_mul_u32_u24 v7, 1152, v7
    v_lshl_add_u32 v7, v2, 4, v7
    s_mul_i32 s4, s46, 96
    s_add_u32 s4, s4, 0
    v_cvt_pk_bf16_f32 v36, v232, v233
    v_cvt_pk_bf16_f32 v37, v234, v235
    v_cvt_pk_bf16_f32 v38, v236, v237
    v_cvt_pk_bf16_f32 v39, v238, v239
    s_nop 0
    v_permlane16_swap_b32 v36, v38
    v_permlane16_swap_b32 v37, v39
    buffer_store_dwordx4 v[36:39], v7, s[36:39], s4 offen offset:0 sc1
    v_cvt_pk_bf16_f32 v40, v240, v241
    v_cvt_pk_bf16_f32 v41, v242, v243
    v_cvt_pk_bf16_f32 v42, v244, v245
    v_cvt_pk_bf16_f32 v43, v246, v247
    s_nop 0
    v_permlane16_swap_b32 v40, v42
    v_permlane16_swap_b32 v41, v43
    buffer_store_dwordx4 v[40:43], v7, s[36:39], s4 offen offset:32 sc1
    v_cvt_pk_bf16_f32 v44, v248, v249
    v_cvt_pk_bf16_f32 v45, v250, v251
    v_cvt_pk_bf16_f32 v46, v252, v253
    v_cvt_pk_bf16_f32 v47, v254, v255
    s_nop 0
    v_permlane16_swap_b32 v44, v46
    v_permlane16_swap_b32 v45, v47
    buffer_store_dwordx4 v[44:47], v7, s[36:39], s4 offen offset:64 sc1
    s_branch GF_EDONE
GF_EK:
    v_cvt_pk_bf16_f32 v44, v232, v233
    v_lshlrev_b32 v45, 16, v44
    v_and_b32 v44, 0xffff0000, v44
    v_mul_f32 v45, 0x3eae1a93, v45
    v_mul_f32 v44, 0x3eae1a93, v44
    v_cvt_pk_bf16_f32 v36, v45, v44
    v_cvt_pk_bf16_f32 v44, v234, v235
    v_lshlrev_b32 v45, 16, v44
    v_and_b32 v44, 0xffff0000, v44
    v_mul_f32 v45, 0x3eae1a93, v45
    v_mul_f32 v44, 0x3eae1a93, v44
    v_cvt_pk_bf16_f32 v37, v45, v44
    v_cvt_pk_bf16_f32 v44, v236, v237
    v_lshlrev_b32 v45, 16, v44
    v_and_b32 v44, 0xffff0000, v44
    v_mul_f32 v45, 0x3eae1a93, v45
    v_mul_f32 v44, 0x3eae1a93, v44
    v_cvt_pk_bf16_f32 v38, v45, v44
    v_cvt_pk_bf16_f32 v44, v238, v239
    v_lshlrev_b32 v45, 16, v44
    v_and_b32 v44, 0xffff0000, v44
    v_mul_f32 v45, 0x3eae1a93, v45
    v_mul_f32 v44, 0x3eae1a93, v44
    v_cvt_pk_bf16_f32 v39, v45, v44
    v_cvt_pk_bf16_f32 v44, v240, v241
    v_lshlrev_b32 v45, 16, v44
    v_and_b32 v44, 0xffff0000, v44
    v_mul_f32 v45, 0x3eae1a93, v45
    v_mul_f32 v44, 0x3eae1a93, v44
    v_cvt_pk_bf16_f32 v40, v45, v44
    v_cvt_pk_bf16_f32 v44, v244, v245
    v_lshlrev_b32 v45, 16, v44
    v_and_b32 v44, 0xffff0000, v44
    v_mul_f32 v45, 0x3eae1a93, v45
    v_mul_f32 v44, 0x3eae1a93, v44
    v_cvt_pk_bf16_f32 v41, v45, v44
    s_mul_i32 s7, s7, 1152
    s_add_u32 s6, s6, s7
    v_permlane16_swap_b32 v36, v38
    v_permlane16_swap_b32 v37, v39
    v_lshl_add_u32 v7, v2, 5, v7
    v_lshlrev_b32 v7, 4, v7
    buffer_store_dwordx4 v[36:39], v7, s[36:39], s6 offen sc1
    v_lshlrev_b32 v6, 2, v6
    s_mov_b64 exec, 0xffff
    buffer_store_dword v40, v6, s[36:39], s6 offen offset:1024 sc1
    buffer_store_dword v41, v6, s[36:39], s6 offen offset:1040 sc1
    s_lshl_b32 s64, s3, 2
    s_add_u32 s64, s64, 41164800
    s_mov_b32 s65, 0xffff
    s_branch GF_EDONE
GF_EV:
    s_lshr_b32 s4, s3, 1
    s_add_u32 s4, s4, 1
    s_mul_i32 s4, s4, 4608
    s_and_b32 s5, s3, 1
    s_mul_i32 s5, s5, 1152
    s_add_u32 s4, s4, s5
    s_add_u32 s4, s4, 4720896
    s_mul_i32 s5, s47, 2048
    s_add_u32 s5, s5, 151552
    v_lshrrev_b32 v6, 3, v5
    v_mul_u32_u24 v6, 576, v6
    v_add_u32 v6, s5, v6
    v_lshl_add_u32 v6, v4, 6, v6
    v_and_b32 v7, 7, v5
    v_lshl_add_u32 v6, v7, 1, v6
    s_lshl_b32 s64, s3, 2
    s_add_u32 s64, s64, 41165056
    s_mov_b32 s65, 0xffff
    v_cvt_pk_bf16_f32 v36, v232, v233
    v_cvt_pk_bf16_f32 v37, v234, v235
    v_cvt_pk_bf16_f32 v38, v240, v241
    ds_write_b16 v6, v36 offset:0
    ds_write_b16_d16_hi v6, v36 offset:16
    ds_write_b16 v6, v37 offset:32
    ds_write_b16_d16_hi v6, v37 offset:48
    v_cvt_pk_bf16_f32 v40, v236, v237
    v_cvt_pk_bf16_f32 v41, v238, v239
    v_cvt_pk_bf16_f32 v42, v244, v245
    ds_write_b16 v6, v40 offset:288
    ds_write_b16_d16_hi v6, v40 offset:304
    ds_write_b16 v6, v41 offset:320
    ds_write_b16_d16_hi v6, v41 offset:336
    s_mov_b64 exec, 0xffff
    ds_write_b16 v6, v38 offset:256
    ds_write_b16_d16_hi v6, v38 offset:272
    ds_write_b16 v6, v42 offset:544
    ds_write_b16_d16_hi v6, v42 offset:560
    s_mov_b64 exec, -1
    v_lshlrev_b32 v7, 4, v0
    v_add_u32 v6, s5, v7
    s_waitcnt lgkmcnt(0)
    ds_read_b128 v[44:47], v6
    ds_read_b128 v[48:51], v6 offset:1024
    s_waitcnt lgkmcnt(0)
    buffer_store_dwordx4 v[44:47], v7, s[36:39], s4 offen sc1
    s_mov_b64 exec, 0xff
    buffer_store_dwordx4 v[48:51], v7, s[36:39], s4 offen offset:1024 sc1
GF_EDONE:
    s_mov_b64 exec, -1
    v_lshrrev_b32 v5, 3, v0
    v_and_b32 v2, 7, v0
    v_lshrrev_b32 v6, 1, v5
    v_xor_b32 v2, v2, v6
    v_lshrrev_b32 v6, 2, v5
    v_and_b32 v5, 3, v5
    v_lshl_add_u32 v5, v6, 3, v5
    s_lshl_b32 s15, s3, 5
    v_add_u32 v5, s15, v5
    v_lshlrev_b32 v5, 12, v5
    v_lshl_add_u32 v76, v2, 4, v5
    v_xor_b32 v77, 64, v76
    v_add_u32 v78, 14336, v76
    v_add_u32 v79, 78848, v77
    v_add_u32 v77, 64512, v77
    s_lshl_b32 s54, s44, 8
    s_lshl_b32 s5, s47, 12
    s_mov_b32 m0, s5
    s_nop 0
    buffer_load_dwordx4 v76, s[24:27], s54 offen offset:0 lds
    buffer_load_dwordx4 v77, s[24:27], s54 offen offset:1024 lds
    buffer_load_dwordx4 v78, s[24:27], s54 offen offset:2048 lds
    buffer_load_dwordx4 v79, s[24:27], s54 offen offset:3072 lds
    s_add_u32 s54, s54, 128
    s_add_u32 m0, s5, 40960
    s_nop 0
    buffer_load_dwordx4 v76, s[24:27], s54 offen offset:0 lds
    buffer_load_dwordx4 v77, s[24:27], s54 offen offset:1024 lds
    buffer_load_dwordx4 v78, s[24:27], s54 offen offset:2048 lds
    buffer_load_dwordx4 v79, s[24:27], s54 offen offset:3072 lds
    s_waitcnt vmcnt(8)
    s_mov_b32 exec_lo, s65
    s_mov_b32 exec_hi, 0
    buffer_store_dword v15, v80, s[36:39], s64 offen sc1
    s_mov_b64 exec, -1
    s_setprio 1
    v_mov_b32 v146, v15
    s_cmp_lg_u32 s47, 0
    s_cbranch_scc1 GF_NOINV
GF_NOINV:
    s_lshl_b32 s3, s44, 7
    s_lshl_b32 s4, s45, 3
    s_add_u32 s3, s3, s4
    s_lshl_b32 s4, s47, 1
    s_add_u32 s3, s3, s4
    s_mul_i32 s4, s3, 1152
    v_and_b32 v1, 31, v0
    v_lshrrev_b32 v2, 5, v0
    v_mul_u32_u24 v3, 36, v1
    v_lshl_add_u32 v4, v2, 4, v3
    v_lshl_add_u32 v5, v2, 30, v3
    s_add_u32 s5, s4, 0
    v_lshlrev_b32 v52, 4, v0
    v_lshlrev_b32 v53, 2, v1
    s_mov_b32 s6, 4718592
    s_mov_b32 s7, 4723200
    v_mov_b32 v7, 0
    v_lshl_add_u32 v6, v2, 3, v3
    v_mul_u32_u24 v60, 18, v2
    v_add_u32 v60, v60, v1
    v_lshlrev_b32 v54, 4, v60
    s_mov_b32 s62, 0x3ffff
    s_mov_b32 s63, 0x3ffff
    s_lshr_b32 s14, s3, 5
    s_lshl_b32 s14, s14, 6
    s_add_u32 s14, s14, 41160704
    s_lshl_b32 s15, s44, 9
    s_add_u32 s15, s15, 41164800
    s_lshl_b32 s16, s3, 3
    s_add_u32 s16, s16, 41177088
    v_min_u32 v60, 11, v0
    v_lshlrev_b32 v60, 2, v60
    v_lshlrev_b32 v61, 3, v0
    v_mov_b32 v62, 162880
    s_waitcnt vmcnt(0)
    s_mov_b64 exec, 1
    ds_add_u32 v62, v85
    s_mov_b64 exec, -1
    v_mov_b32 v32, 0
    v_mov_b32 v33, 0
    v_mov_b32 v34, 0
    v_mov_b32 v35, 0
    v_mov_b32 v40, 0
    v_mov_b32 v41, 0
    v_mov_b32 v42, 0
    v_mov_b32 v43, 0
    v_mov_b32 v36, 0
    v_mov_b32 v37, 0
    v_mov_b32 v38, 0
    v_mov_b32 v39, 0
    v_mov_b32 v136, 0
    v_mov_b32 v137, 0
    v_mov_b32 v138, 0
    v_mov_b32 v139, 0
    s_mov_b32 exec_lo, 0x00140000
    s_mov_b32 exec_hi, 0x00140000
    v_mov_b32 v32, 0x3f803f80
    v_mov_b32 v33, 0x3f803f80
    v_mov_b32 v34, 0x3f803f80
    v_mov_b32 v35, 0x3f803f80
    v_mov_b32 v40, 0x3f803f80
    v_mov_b32 v41, 0x3f803f80
    v_mov_b32 v42, 0x3f803f80
    v_mov_b32 v43, 0x3f803f80
    v_mov_b32 v36, 0x3f803f80
    v_mov_b32 v37, 0x3f803f80
    v_mov_b32 v38, 0x3f803f80
    v_mov_b32 v39, 0x3f803f80
    v_mov_b32 v136, 0x3f803f80
    v_mov_b32 v137, 0x3f803f80
    v_mov_b32 v138, 0x3f803f80
    v_mov_b32 v139, 0x3f803f80
    s_mov_b64 exec, -1
    v_mov_b32 v29, 0x3f803f80
    v_mov_b32 v30, 0x00003f80
    v_mov_b32 v31, 0
    v_mov_b32 v133, 0x3f803f80
    v_mov_b32 v134, 0x00003f80
    v_mov_b32 v135, 0
    v_mov_b32 v13, 0
    v_mov_b32 v14, 0
    v_mov_b32 v15, 0
    v_mov_b32 v21, 0
    v_mov_b32 v22, 0
    v_mov_b32 v23, 0
    v_mov_b32 v44, 0
    v_mov_b32 v45, 0
    v_mov_b32 v46, 0
    v_mov_b32 v47, 0
    v_mov_b32 v48, 0
    v_mov_b32 v49, 0
    v_mov_b32 v50, 0
    v_mov_b32 v51, 0
    s_mov_b32 s52, 0
    s_cmp_eq_u32 s47, 0
    s_cbranch_scc1 GF_AP
    v_mov_b32 v62, 162816
GF_AW:
    s_sleep 2
    ds_read_b32 v63, v62
    s_waitcnt lgkmcnt(0)
    v_cmp_eq_u32 vcc, 0, v63
    s_nop 1
    s_cbranch_vccnz GF_AW
    s_branch GF_AD
GF_AP:
    s_sleep 6
    buffer_load_dword v62, v60, s[36:39], s14 offen sc1
    buffer_load_dwordx2 v[58:59], v61, s[36:39], s15 offen sc1
    s_add_u32 s52, s52, 1
    s_waitcnt vmcnt(0)
    v_xor_b32 v62, v146, v62
    v_xor_b32 v58, v146, v58
    v_xor_b32 v59, v146, v59
    v_or3_b32 v62, v62, v58, v59
    v_cmp_ne_u32 vcc, 0, v62
    s_nop 1
    s_cbranch_vccz GF_AK
    s_cmp_lt_u32 s52, 0x40000
    s_cbranch_scc1 GF_AP
GF_AK:
    v_mov_b32 v62, 162816
    s_mov_b64 exec, 1
    ds_add_u32 v62, v85
    s_mov_b64 exec, -1
GF_AD:
    buffer_load_dwordx4 v[8:11], v4, s[36:39], s5 offen sc1
    buffer_load_dwordx4 v[24:27], v52, s[36:39], s6 offen offset:1152 sc1
    buffer_load_dwordx4 v[16:19], v4, s[36:39], s5 offen offset:1152 sc1
    buffer_load_dword v12, v5, s[36:39], s5 offen offset:32 sc1
    buffer_load_dword v20, v5, s[36:39], s5 offen offset:1184 sc1
    buffer_load_dword v28, v53, s[36:39], s6 offen offset:2176 sc1
    buffer_load_dwordx4 v[128:131], v52, s[36:39], s7 offen sc1
    buffer_load_dword v132, v53, s[36:39], s7 offen offset:1024 sc1
    buffer_load_dwordx4 v[148:151], v7, s[36:39], s16 offen sc1
    v_mov_b32 v62, 162880
GF_ADW:
    s_sleep 2
    ds_read_b32 v63, v62
    s_waitcnt lgkmcnt(0)
    v_cmp_gt_u32 vcc, 8, v63
    s_nop 1
    s_cbranch_vccnz GF_ADW
    s_lshl_b32 s14, s47, 10
    s_add_u32 m0, s14, 122880
    s_add_u32 s14, s14, s7
    buffer_load_dwordx4 v52, s[36:39], s14 offen sc1 lds
    s_add_u32 m0, m0, 4096
    s_add_u32 s14, s14, 4096
    buffer_load_dwordx4 v52, s[36:39], s14 offen sc1 lds
    s_add_u32 m0, m0, 4096
    s_add_u32 s14, s14, 4096
    buffer_load_dwordx4 v52, s[36:39], s14 offen sc1 lds
    s_add_u32 m0, m0, 4096
    s_add_u32 s14, s14, 4096
    buffer_load_dwordx4 v52, s[36:39], s14 offen sc1 lds
    s_lshr_b32 s14, s47, 1
    s_and_b32 s15, s47, 1
    s_lshl_b32 s15, s15, 11
    s_mul_i32 s17, s14, 40960
    s_add_u32 s17, s17, s15
    s_add_u32 m0, s17, 34816
    s_mul_i32 s14, s14, 4608
    s_add_u32 s14, s14, s15
    s_add_u32 s14, s14, 4737024
    buffer_load_dwordx4 v52, s[36:39], s14 offen sc1 lds
    buffer_load_dwordx4 v52, s[36:39], s14 offen offset:1024 sc1 lds
    buffer_load_dwordx4 v52, s[36:39], s14 offen offset:2048 sc1 lds
    v_add_u32 v143, 122880, v52
    v_add_u32 v144, 123904, v53
    v_add_u32 v145, 125184, v54
    v_and_b32 v82, 3, v0
    v_mul_u32_u24 v82, 260, v82
    v_add_u32 v82, 80896, v82
    s_waitcnt vmcnt(7)
    v_mfma_f32_32x32x16_bf16 v[160:175], v[24:27], v[8:11], 0
    v_mfma_f32_32x32x16_bf16 v[160:175], v[28:31], v[12:15], v[160:175]
    v_mfma_f32_32x32x16_bf16 v[176:191], v[24:27], v[16:19], 0
    v_mfma_f32_32x32x16_bf16 v[176:191], v[28:31], v[20:23], v[176:191]
    v_mfma_f32_32x32x16_bf16 v[96:111], v[128:131], v[8:11], 0
    v_mfma_f32_32x32x16_bf16 v[96:111], v[132:135], v[12:15], v[96:111]
    v_mfma_f32_32x32x16_bf16 v[112:127], v[128:131], v[16:19], 0
    v_mfma_f32_32x32x16_bf16 v[112:127], v[132:135], v[20:23], v[112:127]
    s_nop 5
    v_max3_f32 v58, v160, v161, v162
    v_max_f32 v58, v58, v163
    v_max3_f32 v58, v58, v164, v165
    v_max3_f32 v58, v58, v166, v167
    v_max3_f32 v58, v58, v168, v169
    v_max3_f32 v58, v58, v170, v171
    v_max3_f32 v58, v58, v172, v173
    v_max3_f32 v58, v58, v174, v175
    v_max3_f32 v58, v58, v96, v97
    v_max3_f32 v58, v58, v98, v99
    v_max3_f32 v58, v58, v100, v101
    v_max3_f32 v58, v58, v102, v103
    v_max3_f32 v58, v58, v104, v105
    v_max3_f32 v58, v58, v106, v107
    v_max3_f32 v58, v58, v108, v109
    v_max3_f32 v58, v58, v110, v111
    v_max3_f32 v59, v176, v177, v178
    v_max_f32 v59, v59, v179
    v_max3_f32 v59, v59, v180, v181
    v_max3_f32 v59, v59, v182, v183
    v_max3_f32 v59, v59, v184, v185
    v_max3_f32 v59, v59, v186, v187
    v_max3_f32 v59, v59, v188, v189
    v_max3_f32 v59, v59, v190, v191
    v_max3_f32 v59, v59, v112, v113
    v_max3_f32 v59, v59, v114, v115
    v_max3_f32 v59, v59, v116, v117
    v_max3_f32 v59, v59, v118, v119
    v_max3_f32 v59, v59, v120, v121
    v_max3_f32 v59, v59, v122, v123
    v_max3_f32 v59, v59, v124, v125
    v_max3_f32 v59, v59, v126, v127
    v_mov_b32 v60, v58
    s_nop 1
    v_permlane32_swap_b32 v58, v60
    v_max_f32 v58, v58, v60
    v_sub_f32 v58, 0xc2ac0000, v58
    v_cvt_pk_bf16_f32 v60, v58, v58
    v_and_b32 v60, 0xffff0000, v60
    v_sub_f32 v58, v58, v60
    v_cvt_pk_bf16_f32 v61, v58, v58
    v_and_b32 v61, 0xffff0000, v61
    v_sub_f32 v58, v58, v61
    v_lshrrev_b32 v60, 16, v60
    s_mov_b32 exec_hi, 0
    v_or_b32 v13, v60, v61
    v_cvt_pk_bf16_f32 v14, v58, v7
    s_mov_b64 exec, -1
    v_mov_b32 v60, v59
    s_nop 1
    v_permlane32_swap_b32 v59, v60
    v_max_f32 v59, v59, v60
    v_sub_f32 v59, 0xc2ac0000, v59
    v_cvt_pk_bf16_f32 v60, v59, v59
    v_and_b32 v60, 0xffff0000, v60
    v_sub_f32 v59, v59, v60
    v_cvt_pk_bf16_f32 v61, v59, v59
    v_and_b32 v61, 0xffff0000, v61
    v_sub_f32 v59, v59, v61
    v_lshrrev_b32 v60, 16, v60
    s_mov_b32 exec_hi, 0
    v_or_b32 v21, v60, v61
    v_cvt_pk_bf16_f32 v22, v59, v7
    s_mov_b64 exec, -1
    v_mfma_f32_32x32x16_bf16 v[160:175], v[24:27], v[8:11], 0
    v_mfma_f32_32x32x16_bf16 v[160:175], v[28:31], v[12:15], v[160:175]
    v_mov_b32 v96, 0
    v_mov_b32 v97, 0
    v_mov_b32 v98, 0
    v_mov_b32 v99, 0
    v_mov_b32 v100, 0
    v_mov_b32 v101, 0
    v_mov_b32 v102, 0
    v_mov_b32 v103, 0
    v_mov_b32 v104, 0
    v_mov_b32 v105, 0
    v_mov_b32 v106, 0
    v_mov_b32 v107, 0
    v_mov_b32 v108, 0
    v_mov_b32 v109, 0
    v_mov_b32 v110, 0
    v_mov_b32 v111, 0
    v_mov_b32 v112, 0
    v_mov_b32 v113, 0
    v_mov_b32 v114, 0
    v_mov_b32 v115, 0
    v_mov_b32 v116, 0
    v_mov_b32 v117, 0
    v_mov_b32 v118, 0
    v_mov_b32 v119, 0
    v_mov_b32 v120, 0
    v_mov_b32 v121, 0
    v_mov_b32 v122, 0
    v_mov_b32 v123, 0
    v_mov_b32 v124, 0
    v_mov_b32 v125, 0
    v_mov_b32 v126, 0
    v_mov_b32 v127, 0
    v_add_u32 v52, 34816, v52
    v_add_u32 v53, 35840, v53
    v_add_u32 v54, 37120, v54
    v_add_u32 v140, 81920, v52
    v_add_u32 v141, 81920, v53
    v_add_u32 v142, 81920, v54
    s_waitcnt vmcnt(0)
    ds_add_u32 v84, v85
    s_mov_b32 s52, 1
GF_AW0:
    s_sleep 1
    ds_read_b32 v83, v82
    s_waitcnt lgkmcnt(0)
    v_cmp_gt_u32 vcc, s52, v83
    s_nop 1
    s_cbranch_vccnz GF_AW0
    s_setprio 1
    s_mov_b64 exec, s[62:63]
    ds_read_b128 v[32:35], v145 offset:0
    ds_read_b128 v[36:39], v145 offset:576
    s_mov_b64 exec, -1
    s_mov_b32 s51, 3
    v_mov_b32 v82, 40704
    s_nop 4
    s_branch GF_PMID
GF_PL:
    v_mfma_f32_32x32x16_bf16 v[160:175], v[24:27], v[8:11], 0
    s_mov_b64 exec, s[62:63]
    ds_read_b128 v[32:35], v145 offset:0
    ds_read_b128 v[36:39], v145 offset:576
    s_mov_b64 exec, -1
    v_exp_f32 v176, v176
    v_exp_f32 v177, v177
    v_exp_f32 v178, v178
    v_exp_f32 v179, v179
    v_cvt_pk_bf16_f32 v44, v176, v177
    v_cvt_pk_bf16_f32 v45, v178, v179
    v_mfma_f32_32x32x16_bf16 v[160:175], v[28:31], v[12:15], v[160:175]
    ds_read_b128 v[128:131], v143 offset:0
    ds_read_b32 v132, v144 offset:0
    v_exp_f32 v180, v180
    v_exp_f32 v181, v181
    v_exp_f32 v182, v182
    v_exp_f32 v183, v183
    v_cvt_pk_bf16_f32 v46, v180, v181
    v_cvt_pk_bf16_f32 v47, v182, v183
    v_mfma_f32_32x32x16_bf16 v[96:111], v[136:139], v[48:51], v[96:111]
    v_exp_f32 v184, v184
    v_exp_f32 v185, v185
    v_exp_f32 v186, v186
    v_exp_f32 v187, v187
    v_cvt_pk_bf16_f32 v48, v184, v185
    v_cvt_pk_bf16_f32 v49, v186, v187
    v_mfma_f32_32x32x16_bf16 v[112:127], v[40:43], v[44:47], v[112:127]
    v_exp_f32 v188, v188
    v_exp_f32 v189, v189
    v_exp_f32 v190, v190
    v_exp_f32 v191, v191
    v_cvt_pk_bf16_f32 v50, v188, v189
    v_cvt_pk_bf16_f32 v51, v190, v191
GF_PMID:
    v_mfma_f32_32x32x16_bf16 v[176:191], v[24:27], v[16:19], 0
    v_exp_f32 v160, v160
    v_exp_f32 v161, v161
    v_exp_f32 v162, v162
    v_exp_f32 v163, v163
    v_cvt_pk_bf16_f32 v44, v160, v161
    v_cvt_pk_bf16_f32 v45, v162, v163
    v_mfma_f32_32x32x16_bf16 v[176:191], v[28:31], v[20:23], v[176:191]
    v_exp_f32 v164, v164
    v_exp_f32 v165, v165
    v_exp_f32 v166, v166
    v_exp_f32 v167, v167
    v_cvt_pk_bf16_f32 v46, v164, v165
    v_cvt_pk_bf16_f32 v47, v166, v167
    v_mfma_f32_32x32x16_bf16 v[112:127], v[136:139], v[48:51], v[112:127]
    v_exp_f32 v168, v168
    v_exp_f32 v169, v169
    v_exp_f32 v170, v170
    v_exp_f32 v171, v171
    v_cvt_pk_bf16_f32 v48, v168, v169
    v_cvt_pk_bf16_f32 v49, v170, v171
    s_waitcnt lgkmcnt(0)
    v_mfma_f32_32x32x16_bf16 v[96:111], v[32:35], v[44:47], v[96:111]
    v_exp_f32 v172, v172
    v_exp_f32 v173, v173
    v_exp_f32 v174, v174
    v_exp_f32 v175, v175
    v_cvt_pk_bf16_f32 v50, v172, v173
    v_cvt_pk_bf16_f32 v51, v174, v175
    v_mfma_f32_32x32x16_bf16 v[160:175], v[128:131], v[8:11], 0
    s_mov_b64 exec, s[62:63]
    ds_read_b128 v[40:43], v145 offset:1152
    ds_read_b128 v[136:139], v145 offset:1728
    s_mov_b64 exec, -1
    v_exp_f32 v176, v176
    v_exp_f32 v177, v177
    v_exp_f32 v178, v178
    v_exp_f32 v179, v179
    v_cvt_pk_bf16_f32 v44, v176, v177
    v_cvt_pk_bf16_f32 v45, v178, v179
    v_mfma_f32_32x32x16_bf16 v[160:175], v[132:135], v[12:15], v[160:175]
    ds_read_b128 v[24:27], v143 offset:1152
    ds_read_b32 v28, v144 offset:1152
    v_exp_f32 v180, v180
    v_exp_f32 v181, v181
    v_exp_f32 v182, v182
    v_exp_f32 v183, v183
    v_cvt_pk_bf16_f32 v46, v180, v181
    v_cvt_pk_bf16_f32 v47, v182, v183
    v_mfma_f32_32x32x16_bf16 v[96:111], v[36:39], v[48:51], v[96:111]
    v_exp_f32 v184, v184
    v_exp_f32 v185, v185
    v_exp_f32 v186, v186
    v_exp_f32 v187, v187
    v_cvt_pk_bf16_f32 v48, v184, v185
    v_cvt_pk_bf16_f32 v49, v186, v187
    v_mfma_f32_32x32x16_bf16 v[112:127], v[32:35], v[44:47], v[112:127]
    v_exp_f32 v188, v188
    v_exp_f32 v189, v189
    v_exp_f32 v190, v190
    v_exp_f32 v191, v191
    v_cvt_pk_bf16_f32 v50, v188, v189
    v_cvt_pk_bf16_f32 v51, v190, v191
    v_mfma_f32_32x32x16_bf16 v[176:191], v[128:131], v[16:19], 0
    v_exp_f32 v160, v160
    v_exp_f32 v161, v161
    v_exp_f32 v162, v162
    v_exp_f32 v163, v163
    v_cvt_pk_bf16_f32 v44, v160, v161
    v_cvt_pk_bf16_f32 v45, v162, v163
    v_mfma_f32_32x32x16_bf16 v[176:191], v[132:135], v[20:23], v[176:191]
    v_exp_f32 v164, v164
    v_exp_f32 v165, v165
    v_exp_f32 v166, v166
    v_exp_f32 v167, v167
    v_cvt_pk_bf16_f32 v46, v164, v165
    v_cvt_pk_bf16_f32 v47, v166, v167
    v_mfma_f32_32x32x16_bf16 v[112:127], v[36:39], v[48:51], v[112:127]
    v_exp_f32 v168, v168
    v_exp_f32 v169, v169
    v_exp_f32 v170, v170
    v_exp_f32 v171, v171
    v_cvt_pk_bf16_f32 v48, v168, v169
    v_cvt_pk_bf16_f32 v49, v170, v171
    s_waitcnt lgkmcnt(0)
    v_mfma_f32_32x32x16_bf16 v[96:111], v[40:43], v[44:47], v[96:111]
    v_add_u32 v143, 4608, v143
    v_add_u32 v144, 4608, v144
    v_add_u32 v145, 4608, v145
    v_exp_f32 v172, v172
    v_exp_f32 v173, v173
    v_exp_f32 v174, v174
    v_exp_f32 v175, v175
    v_cvt_pk_bf16_f32 v50, v172, v173
    v_cvt_pk_bf16_f32 v51, v174, v175
    s_sub_u32 s51, s51, 1
    s_cmp_lg_u32 s51, 0
    s_cbranch_scc1 GF_PL
    ds_add_u32 v84, v85
GF_ASPIN0:
    s_sleep 1
    ds_read_b32 v83, v82
    s_waitcnt lgkmcnt(0)
    v_cmp_gt_u32 vcc, s52, v83
    s_nop 1
    s_cbranch_vccnz GF_ASPIN0
    s_branch GF_AL0
GF_ASPIN1:
    s_sleep 1
    ds_read_b32 v83, v82
    s_waitcnt lgkmcnt(0)
    v_cmp_gt_u32 vcc, s52, v83
    s_nop 1
    s_cbranch_vccnz GF_ASPIN1
    s_branch GF_AL1
GF_ASPIN2:
    s_sleep 1
    ds_read_b32 v83, v82
    s_waitcnt lgkmcnt(0)
    v_cmp_gt_u32 vcc, s52, v83
    s_nop 1
    s_cbranch_vccnz GF_ASPIN2
    s_branch GF_AL2
GF_ASPIN3:
    s_sleep 1
    ds_read_b32 v83, v82
    s_waitcnt lgkmcnt(0)
    v_cmp_gt_u32 vcc, s52, v83
    s_nop 1
    s_cbranch_vccnz GF_ASPIN3
    s_branch GF_AL3
GF_AL0:
    v_mfma_f32_32x32x16_bf16 v[160:175], v[24:27], v[8:11], 0
    s_mov_b64 exec, s[62:63]
    ds_read_b128 v[32:35], v54 offset:0
    ds_read_b128 v[36:39], v54 offset:576
    s_mov_b64 exec, -1
    v_exp_f32 v176, v176
    v_exp_f32 v177, v177
    v_exp_f32 v178, v178
    v_exp_f32 v179, v179
    v_cvt_pk_bf16_f32 v44, v176, v177
    v_cvt_pk_bf16_f32 v45, v178, v179
    v_mfma_f32_32x32x16_bf16 v[160:175], v[28:31], v[12:15], v[160:175]
    ds_read_b128 v[128:131], v52 offset:0
    ds_read_b32 v132, v53 offset:0
    v_exp_f32 v180, v180
    v_exp_f32 v181, v181
    v_exp_f32 v182, v182
    v_exp_f32 v183, v183
    v_cvt_pk_bf16_f32 v46, v180, v181
    v_cvt_pk_bf16_f32 v47, v182, v183
    v_mfma_f32_32x32x16_bf16 v[96:111], v[136:139], v[48:51], v[96:111]
    v_exp_f32 v184, v184
    v_exp_f32 v185, v185
    v_exp_f32 v186, v186
    v_exp_f32 v187, v187
    v_cvt_pk_bf16_f32 v48, v184, v185
    v_cvt_pk_bf16_f32 v49, v186, v187
    v_mfma_f32_32x32x16_bf16 v[112:127], v[40:43], v[44:47], v[112:127]
    v_exp_f32 v188, v188
    v_exp_f32 v189, v189
    v_exp_f32 v190, v190
    v_exp_f32 v191, v191
    v_cvt_pk_bf16_f32 v50, v188, v189
    v_cvt_pk_bf16_f32 v51, v190, v191
    v_mfma_f32_32x32x16_bf16 v[176:191], v[24:27], v[16:19], 0
    v_exp_f32 v160, v160
    v_exp_f32 v161, v161
    v_exp_f32 v162, v162
    v_exp_f32 v163, v163
    v_cvt_pk_bf16_f32 v44, v160, v161
    v_cvt_pk_bf16_f32 v45, v162, v163
    v_mfma_f32_32x32x16_bf16 v[176:191], v[28:31], v[20:23], v[176:191]
    v_exp_f32 v164, v164
    v_exp_f32 v165, v165
    v_exp_f32 v166, v166
    v_exp_f32 v167, v167
    v_cvt_pk_bf16_f32 v46, v164, v165
    v_cvt_pk_bf16_f32 v47, v166, v167
    v_mfma_f32_32x32x16_bf16 v[112:127], v[136:139], v[48:51], v[112:127]
    v_exp_f32 v168, v168
    v_exp_f32 v169, v169
    v_exp_f32 v170, v170
    v_exp_f32 v171, v171
    v_cvt_pk_bf16_f32 v48, v168, v169
    v_cvt_pk_bf16_f32 v49, v170, v171
    s_waitcnt lgkmcnt(0)
    v_mfma_f32_32x32x16_bf16 v[96:111], v[32:35], v[44:47], v[96:111]
    v_exp_f32 v172, v172
    v_exp_f32 v173, v173
    v_exp_f32 v174, v174
    v_exp_f32 v175, v175
    v_cvt_pk_bf16_f32 v50, v172, v173
    v_cvt_pk_bf16_f32 v51, v174, v175
    v_mfma_f32_32x32x16_bf16 v[160:175], v[128:131], v[8:11], 0
    s_mov_b64 exec, s[62:63]
    ds_read_b128 v[40:43], v54 offset:1152
    ds_read_b128 v[136:139], v54 offset:1728
    s_mov_b64 exec, -1
    v_exp_f32 v176, v176
    v_exp_f32 v177, v177
    v_exp_f32 v178, v178
    v_exp_f32 v179, v179
    v_cvt_pk_bf16_f32 v44, v176, v177
    v_cvt_pk_bf16_f32 v45, v178, v179
    v_mfma_f32_32x32x16_bf16 v[160:175], v[132:135], v[12:15], v[160:175]
    ds_read_b128 v[24:27], v52 offset:1152
    ds_read_b32 v28, v53 offset:1152
    v_exp_f32 v180, v180
    v_exp_f32 v181, v181
    v_exp_f32 v182, v182
    v_exp_f32 v183, v183
    v_cvt_pk_bf16_f32 v46, v180, v181
    v_cvt_pk_bf16_f32 v47, v182, v183
    v_mfma_f32_32x32x16_bf16 v[96:111], v[36:39], v[48:51], v[96:111]
    v_exp_f32 v184, v184
    v_exp_f32 v185, v185
    v_exp_f32 v186, v186
    v_exp_f32 v187, v187
    v_cvt_pk_bf16_f32 v48, v184, v185
    v_cvt_pk_bf16_f32 v49, v186, v187
    v_mfma_f32_32x32x16_bf16 v[112:127], v[32:35], v[44:47], v[112:127]
    v_exp_f32 v188, v188
    v_exp_f32 v189, v189
    v_exp_f32 v190, v190
    v_exp_f32 v191, v191
    v_cvt_pk_bf16_f32 v50, v188, v189
    v_cvt_pk_bf16_f32 v51, v190, v191
    v_mfma_f32_32x32x16_bf16 v[176:191], v[128:131], v[16:19], 0
    ds_read_b32 v83, v82
    v_exp_f32 v160, v160
    v_exp_f32 v161, v161
    v_exp_f32 v162, v162
    v_exp_f32 v163, v163
    v_cvt_pk_bf16_f32 v44, v160, v161
    v_cvt_pk_bf16_f32 v45, v162, v163
    v_mfma_f32_32x32x16_bf16 v[176:191], v[132:135], v[20:23], v[176:191]
    v_exp_f32 v164, v164
    v_exp_f32 v165, v165
    v_exp_f32 v166, v166
    v_exp_f32 v167, v167
    v_cvt_pk_bf16_f32 v46, v164, v165
    v_cvt_pk_bf16_f32 v47, v166, v167
    v_mfma_f32_32x32x16_bf16 v[112:127], v[36:39], v[48:51], v[112:127]
    v_exp_f32 v168, v168
    v_exp_f32 v169, v169
    v_exp_f32 v170, v170
    v_exp_f32 v171, v171
    v_cvt_pk_bf16_f32 v48, v168, v169
    v_cvt_pk_bf16_f32 v49, v170, v171
    s_waitcnt lgkmcnt(0)
    v_mfma_f32_32x32x16_bf16 v[96:111], v[40:43], v[44:47], v[96:111]
    ds_add_u32 v84, v85
    v_cmp_ge_u32 vcc, s52, v83
    s_add_u32 s52, s52, 1
    v_exp_f32 v172, v172
    v_exp_f32 v173, v173
    v_exp_f32 v174, v174
    v_exp_f32 v175, v175
    v_cvt_pk_bf16_f32 v50, v172, v173
    v_cvt_pk_bf16_f32 v51, v174, v175
    s_cmp_eq_u32 s52, 30
    s_cbranch_scc1 GF_AEND
    s_cbranch_vccnz GF_ASPIN1
GF_AL1:
    v_mfma_f32_32x32x16_bf16 v[160:175], v[24:27], v[8:11], 0
    s_mov_b64 exec, s[62:63]
    ds_read_b128 v[32:35], v54 offset:40960
    ds_read_b128 v[36:39], v54 offset:41536
    s_mov_b64 exec, -1
    v_exp_f32 v176, v176
    v_exp_f32 v177, v177
    v_exp_f32 v178, v178
    v_exp_f32 v179, v179
    v_cvt_pk_bf16_f32 v44, v176, v177
    v_cvt_pk_bf16_f32 v45, v178, v179
    v_mfma_f32_32x32x16_bf16 v[160:175], v[28:31], v[12:15], v[160:175]
    ds_read_b128 v[128:131], v52 offset:40960
    ds_read_b32 v132, v53 offset:40960
    v_exp_f32 v180, v180
    v_exp_f32 v181, v181
    v_exp_f32 v182, v182
    v_exp_f32 v183, v183
    v_cvt_pk_bf16_f32 v46, v180, v181
    v_cvt_pk_bf16_f32 v47, v182, v183
    v_mfma_f32_32x32x16_bf16 v[96:111], v[136:139], v[48:51], v[96:111]
    v_exp_f32 v184, v184
    v_exp_f32 v185, v185
    v_exp_f32 v186, v186
    v_exp_f32 v187, v187
    v_cvt_pk_bf16_f32 v48, v184, v185
    v_cvt_pk_bf16_f32 v49, v186, v187
    v_mfma_f32_32x32x16_bf16 v[112:127], v[40:43], v[44:47], v[112:127]
    v_exp_f32 v188, v188
    v_exp_f32 v189, v189
    v_exp_f32 v190, v190
    v_exp_f32 v191, v191
    v_cvt_pk_bf16_f32 v50, v188, v189
    v_cvt_pk_bf16_f32 v51, v190, v191
    v_mfma_f32_32x32x16_bf16 v[176:191], v[24:27], v[16:19], 0
    v_exp_f32 v160, v160
    v_exp_f32 v161, v161
    v_exp_f32 v162, v162
    v_exp_f32 v163, v163
    v_cvt_pk_bf16_f32 v44, v160, v161
    v_cvt_pk_bf16_f32 v45, v162, v163
    v_mfma_f32_32x32x16_bf16 v[176:191], v[28:31], v[20:23], v[176:191]
    v_exp_f32 v164, v164
    v_exp_f32 v165, v165
    v_exp_f32 v166, v166
    v_exp_f32 v167, v167
    v_cvt_pk_bf16_f32 v46, v164, v165
    v_cvt_pk_bf16_f32 v47, v166, v167
    v_mfma_f32_32x32x16_bf16 v[112:127], v[136:139], v[48:51], v[112:127]
    v_exp_f32 v168, v168
    v_exp_f32 v169, v169
    v_exp_f32 v170, v170
    v_exp_f32 v171, v171
    v_cvt_pk_bf16_f32 v48, v168, v169
    v_cvt_pk_bf16_f32 v49, v170, v171
    s_waitcnt lgkmcnt(0)
    v_mfma_f32_32x32x16_bf16 v[96:111], v[32:35], v[44:47], v[96:111]
    v_exp_f32 v172, v172
    v_exp_f32 v173, v173
    v_exp_f32 v174, v174
    v_exp_f32 v175, v175
    v_cvt_pk_bf16_f32 v50, v172, v173
    v_cvt_pk_bf16_f32 v51, v174, v175
    v_mfma_f32_32x32x16_bf16 v[160:175], v[128:131], v[8:11], 0
    s_mov_b64 exec, s[62:63]
    ds_read_b128 v[40:43], v54 offset:42112
    ds_read_b128 v[136:139], v54 offset:42688
    s_mov_b64 exec, -1
    v_exp_f32 v176, v176
    v_exp_f32 v177, v177
    v_exp_f32 v178, v178
    v_exp_f32 v179, v179
    v_cvt_pk_bf16_f32 v44, v176, v177
    v_cvt_pk_bf16_f32 v45, v178, v179
    v_mfma_f32_32x32x16_bf16 v[160:175], v[132:135], v[12:15], v[160:175]
    ds_read_b128 v[24:27], v52 offset:42112
    ds_read_b32 v28, v53 offset:42112
    v_exp_f32 v180, v180
    v_exp_f32 v181, v181
    v_exp_f32 v182, v182
    v_exp_f32 v183, v183
    v_cvt_pk_bf16_f32 v46, v180, v181
    v_cvt_pk_bf16_f32 v47, v182, v183
    v_mfma_f32_32x32x16_bf16 v[96:111], v[36:39], v[48:51], v[96:111]
    v_exp_f32 v184, v184
    v_exp_f32 v185, v185
    v_exp_f32 v186, v186
    v_exp_f32 v187, v187
    v_cvt_pk_bf16_f32 v48, v184, v185
    v_cvt_pk_bf16_f32 v49, v186, v187
    v_mfma_f32_32x32x16_bf16 v[112:127], v[32:35], v[44:47], v[112:127]
    v_exp_f32 v188, v188
    v_exp_f32 v189, v189
    v_exp_f32 v190, v190
    v_exp_f32 v191, v191
    v_cvt_pk_bf16_f32 v50, v188, v189
    v_cvt_pk_bf16_f32 v51, v190, v191
    v_mfma_f32_32x32x16_bf16 v[176:191], v[128:131], v[16:19], 0
    ds_read_b32 v83, v82
    v_exp_f32 v160, v160
    v_exp_f32 v161, v161
    v_exp_f32 v162, v162
    v_exp_f32 v163, v163
    v_cvt_pk_bf16_f32 v44, v160, v161
    v_cvt_pk_bf16_f32 v45, v162, v163
    v_mfma_f32_32x32x16_bf16 v[176:191], v[132:135], v[20:23], v[176:191]
    v_exp_f32 v164, v164
    v_exp_f32 v165, v165
    v_exp_f32 v166, v166
    v_exp_f32 v167, v167
    v_cvt_pk_bf16_f32 v46, v164, v165
    v_cvt_pk_bf16_f32 v47, v166, v167
    v_mfma_f32_32x32x16_bf16 v[112:127], v[36:39], v[48:51], v[112:127]
    v_exp_f32 v168, v168
    v_exp_f32 v169, v169
    v_exp_f32 v170, v170
    v_exp_f32 v171, v171
    v_cvt_pk_bf16_f32 v48, v168, v169
    v_cvt_pk_bf16_f32 v49, v170, v171
    s_waitcnt lgkmcnt(0)
    v_mfma_f32_32x32x16_bf16 v[96:111], v[40:43], v[44:47], v[96:111]
    ds_add_u32 v84, v85
    v_cmp_ge_u32 vcc, s52, v83
    s_add_u32 s52, s52, 1
    v_exp_f32 v172, v172
    v_exp_f32 v173, v173
    v_exp_f32 v174, v174
    v_exp_f32 v175, v175
    v_cvt_pk_bf16_f32 v50, v172, v173
    v_cvt_pk_bf16_f32 v51, v174, v175
    s_cbranch_vccnz GF_ASPIN2
GF_AL2:
    v_mfma_f32_32x32x16_bf16 v[160:175], v[24:27], v[8:11], 0
    s_mov_b64 exec, s[62:63]
    ds_read_b128 v[32:35], v142 offset:0
    ds_read_b128 v[36:39], v142 offset:576
    s_mov_b64 exec, -1
    v_exp_f32 v176, v176
    v_exp_f32 v177, v177
    v_exp_f32 v178, v178
    v_exp_f32 v179, v179
    v_cvt_pk_bf16_f32 v44, v176, v177
    v_cvt_pk_bf16_f32 v45, v178, v179
    v_mfma_f32_32x32x16_bf16 v[160:175], v[28:31], v[12:15], v[160:175]
    ds_read_b128 v[128:131], v140 offset:0
    ds_read_b32 v132, v141 offset:0
    v_exp_f32 v180, v180
    v_exp_f32 v181, v181
    v_exp_f32 v182, v182
    v_exp_f32 v183, v183
    v_cvt_pk_bf16_f32 v46, v180, v181
    v_cvt_pk_bf16_f32 v47, v182, v183
    v_mfma_f32_32x32x16_bf16 v[96:111], v[136:139], v[48:51], v[96:111]
    v_exp_f32 v184, v184
    v_exp_f32 v185, v185
    v_exp_f32 v186, v186
    v_exp_f32 v187, v187
    v_cvt_pk_bf16_f32 v48, v184, v185
    v_cvt_pk_bf16_f32 v49, v186, v187
    v_mfma_f32_32x32x16_bf16 v[112:127], v[40:43], v[44:47], v[112:127]
    v_exp_f32 v188, v188
    v_exp_f32 v189, v189
    v_exp_f32 v190, v190
    v_exp_f32 v191, v191
    v_cvt_pk_bf16_f32 v50, v188, v189
    v_cvt_pk_bf16_f32 v51, v190, v191
    v_mfma_f32_32x32x16_bf16 v[176:191], v[24:27], v[16:19], 0
    v_exp_f32 v160, v160
    v_exp_f32 v161, v161
    v_exp_f32 v162, v162
    v_exp_f32 v163, v163
    v_cvt_pk_bf16_f32 v44, v160, v161
    v_cvt_pk_bf16_f32 v45, v162, v163
    v_mfma_f32_32x32x16_bf16 v[176:191], v[28:31], v[20:23], v[176:191]
    v_exp_f32 v164, v164
    v_exp_f32 v165, v165
    v_exp_f32 v166, v166
    v_exp_f32 v167, v167
    v_cvt_pk_bf16_f32 v46, v164, v165
    v_cvt_pk_bf16_f32 v47, v166, v167
    v_mfma_f32_32x32x16_bf16 v[112:127], v[136:139], v[48:51], v[112:127]
    v_exp_f32 v168, v168
    v_exp_f32 v169, v169
    v_exp_f32 v170, v170
    v_exp_f32 v171, v171
    v_cvt_pk_bf16_f32 v48, v168, v169
    v_cvt_pk_bf16_f32 v49, v170, v171
    s_waitcnt lgkmcnt(0)
    v_mfma_f32_32x32x16_bf16 v[96:111], v[32:35], v[44:47], v[96:111]
    v_exp_f32 v172, v172
    v_exp_f32 v173, v173
    v_exp_f32 v174, v174
    v_exp_f32 v175, v175
    v_cvt_pk_bf16_f32 v50, v172, v173
    v_cvt_pk_bf16_f32 v51, v174, v175
    v_mfma_f32_32x32x16_bf16 v[160:175], v[128:131], v[8:11], 0
    s_mov_b64 exec, s[62:63]
    ds_read_b128 v[40:43], v142 offset:1152
    ds_read_b128 v[136:139], v142 offset:1728
    s_mov_b64 exec, -1
    v_exp_f32 v176, v176
    v_exp_f32 v177, v177
    v_exp_f32 v178, v178
    v_exp_f32 v179, v179
    v_cvt_pk_bf16_f32 v44, v176, v177
    v_cvt_pk_bf16_f32 v45, v178, v179
    v_mfma_f32_32x32x16_bf16 v[160:175], v[132:135], v[12:15], v[160:175]
    ds_read_b128 v[24:27], v140 offset:1152
    ds_read_b32 v28, v141 offset:1152
    v_exp_f32 v180, v180
    v_exp_f32 v181, v181
    v_exp_f32 v182, v182
    v_exp_f32 v183, v183
    v_cvt_pk_bf16_f32 v46, v180, v181
    v_cvt_pk_bf16_f32 v47, v182, v183
    v_mfma_f32_32x32x16_bf16 v[96:111], v[36:39], v[48:51], v[96:111]
    v_exp_f32 v184, v184
    v_exp_f32 v185, v185
    v_exp_f32 v186, v186
    v_exp_f32 v187, v187
    v_cvt_pk_bf16_f32 v48, v184, v185
    v_cvt_pk_bf16_f32 v49, v186, v187
    v_mfma_f32_32x32x16_bf16 v[112:127], v[32:35], v[44:47], v[112:127]
    v_exp_f32 v188, v188
    v_exp_f32 v189, v189
    v_exp_f32 v190, v190
    v_exp_f32 v191, v191
    v_cvt_pk_bf16_f32 v50, v188, v189
    v_cvt_pk_bf16_f32 v51, v190, v191
    v_mfma_f32_32x32x16_bf16 v[176:191], v[128:131], v[16:19], 0
    ds_read_b32 v83, v82
    v_exp_f32 v160, v160
    v_exp_f32 v161, v161
    v_exp_f32 v162, v162
    v_exp_f32 v163, v163
    v_cvt_pk_bf16_f32 v44, v160, v161
    v_cvt_pk_bf16_f32 v45, v162, v163
    v_mfma_f32_32x32x16_bf16 v[176:191], v[132:135], v[20:23], v[176:191]
    v_exp_f32 v164, v164
    v_exp_f32 v165, v165
    v_exp_f32 v166, v166
    v_exp_f32 v167, v167
    v_cvt_pk_bf16_f32 v46, v164, v165
    v_cvt_pk_bf16_f32 v47, v166, v167
    v_mfma_f32_32x32x16_bf16 v[112:127], v[36:39], v[48:51], v[112:127]
    v_exp_f32 v168, v168
    v_exp_f32 v169, v169
    v_exp_f32 v170, v170
    v_exp_f32 v171, v171
    v_cvt_pk_bf16_f32 v48, v168, v169
    v_cvt_pk_bf16_f32 v49, v170, v171
    s_waitcnt lgkmcnt(0)
    v_mfma_f32_32x32x16_bf16 v[96:111], v[40:43], v[44:47], v[96:111]
    ds_add_u32 v84, v85
    v_cmp_ge_u32 vcc, s52, v83
    s_add_u32 s52, s52, 1
    v_exp_f32 v172, v172
    v_exp_f32 v173, v173
    v_exp_f32 v174, v174
    v_exp_f32 v175, v175
    v_cvt_pk_bf16_f32 v50, v172, v173
    v_cvt_pk_bf16_f32 v51, v174, v175
    s_cbranch_vccnz GF_ASPIN3
GF_AL3:
    v_mfma_f32_32x32x16_bf16 v[160:175], v[24:27], v[8:11], 0
    s_mov_b64 exec, s[62:63]
    ds_read_b128 v[32:35], v142 offset:40960
    ds_read_b128 v[36:39], v142 offset:41536
    s_mov_b64 exec, -1
    v_exp_f32 v176, v176
    v_exp_f32 v177, v177
    v_exp_f32 v178, v178
    v_exp_f32 v179, v179
    v_cvt_pk_bf16_f32 v44, v176, v177
    v_cvt_pk_bf16_f32 v45, v178, v179
    v_mfma_f32_32x32x16_bf16 v[160:175], v[28:31], v[12:15], v[160:175]
    ds_read_b128 v[128:131], v140 offset:40960
    ds_read_b32 v132, v141 offset:40960
    v_exp_f32 v180, v180
    v_exp_f32 v181, v181
    v_exp_f32 v182, v182
    v_exp_f32 v183, v183
    v_cvt_pk_bf16_f32 v46, v180, v181
    v_cvt_pk_bf16_f32 v47, v182, v183
    v_mfma_f32_32x32x16_bf16 v[96:111], v[136:139], v[48:51], v[96:111]
    v_exp_f32 v184, v184
    v_exp_f32 v185, v185
    v_exp_f32 v186, v186
    v_exp_f32 v187, v187
    v_cvt_pk_bf16_f32 v48, v184, v185
    v_cvt_pk_bf16_f32 v49, v186, v187
    v_mfma_f32_32x32x16_bf16 v[112:127], v[40:43], v[44:47], v[112:127]
    v_exp_f32 v188, v188
    v_exp_f32 v189, v189
    v_exp_f32 v190, v190
    v_exp_f32 v191, v191
    v_cvt_pk_bf16_f32 v50, v188, v189
    v_cvt_pk_bf16_f32 v51, v190, v191
    v_mfma_f32_32x32x16_bf16 v[176:191], v[24:27], v[16:19], 0
    v_exp_f32 v160, v160
    v_exp_f32 v161, v161
    v_exp_f32 v162, v162
    v_exp_f32 v163, v163
    v_cvt_pk_bf16_f32 v44, v160, v161
    v_cvt_pk_bf16_f32 v45, v162, v163
    v_mfma_f32_32x32x16_bf16 v[176:191], v[28:31], v[20:23], v[176:191]
    v_exp_f32 v164, v164
    v_exp_f32 v165, v165
    v_exp_f32 v166, v166
    v_exp_f32 v167, v167
    v_cvt_pk_bf16_f32 v46, v164, v165
    v_cvt_pk_bf16_f32 v47, v166, v167
    v_mfma_f32_32x32x16_bf16 v[112:127], v[136:139], v[48:51], v[112:127]
    v_exp_f32 v168, v168
    v_exp_f32 v169, v169
    v_exp_f32 v170, v170
    v_exp_f32 v171, v171
    v_cvt_pk_bf16_f32 v48, v168, v169
    v_cvt_pk_bf16_f32 v49, v170, v171
    s_waitcnt lgkmcnt(0)
    v_mfma_f32_32x32x16_bf16 v[96:111], v[32:35], v[44:47], v[96:111]
    v_exp_f32 v172, v172
    v_exp_f32 v173, v173
    v_exp_f32 v174, v174
    v_exp_f32 v175, v175
    v_cvt_pk_bf16_f32 v50, v172, v173
    v_cvt_pk_bf16_f32 v51, v174, v175
    v_mfma_f32_32x32x16_bf16 v[160:175], v[128:131], v[8:11], 0
    s_mov_b64 exec, s[62:63]
    ds_read_b128 v[40:43], v142 offset:42112
    ds_read_b128 v[136:139], v142 offset:42688
    s_mov_b64 exec, -1
    v_exp_f32 v176, v176
    v_exp_f32 v177, v177
    v_exp_f32 v178, v178
    v_exp_f32 v179, v179
    v_cvt_pk_bf16_f32 v44, v176, v177
    v_cvt_pk_bf16_f32 v45, v178, v179
    v_mfma_f32_32x32x16_bf16 v[160:175], v[132:135], v[12:15], v[160:175]
    ds_read_b128 v[24:27], v140 offset:42112
    ds_read_b32 v28, v141 offset:42112
    v_exp_f32 v180, v180
    v_exp_f32 v181, v181
    v_exp_f32 v182, v182
    v_exp_f32 v183, v183
    v_cvt_pk_bf16_f32 v46, v180, v181
    v_cvt_pk_bf16_f32 v47, v182, v183
    v_mfma_f32_32x32x16_bf16 v[96:111], v[36:39], v[48:51], v[96:111]
    v_exp_f32 v184, v184
    v_exp_f32 v185, v185
    v_exp_f32 v186, v186
    v_exp_f32 v187, v187
    v_cvt_pk_bf16_f32 v48, v184, v185
    v_cvt_pk_bf16_f32 v49, v186, v187
    v_mfma_f32_32x32x16_bf16 v[112:127], v[32:35], v[44:47], v[112:127]
    v_exp_f32 v188, v188
    v_exp_f32 v189, v189
    v_exp_f32 v190, v190
    v_exp_f32 v191, v191
    v_cvt_pk_bf16_f32 v50, v188, v189
    v_cvt_pk_bf16_f32 v51, v190, v191
    v_mfma_f32_32x32x16_bf16 v[176:191], v[128:131], v[16:19], 0
    ds_read_b32 v83, v82
    v_exp_f32 v160, v160
    v_exp_f32 v161, v161
    v_exp_f32 v162, v162
    v_exp_f32 v163, v163
    v_cvt_pk_bf16_f32 v44, v160, v161
    v_cvt_pk_bf16_f32 v45, v162, v163
    v_mfma_f32_32x32x16_bf16 v[176:191], v[132:135], v[20:23], v[176:191]
    v_exp_f32 v164, v164
    v_exp_f32 v165, v165
    v_exp_f32 v166, v166
    v_exp_f32 v167, v167
    v_cvt_pk_bf16_f32 v46, v164, v165
    v_cvt_pk_bf16_f32 v47, v166, v167
    v_mfma_f32_32x32x16_bf16 v[112:127], v[36:39], v[48:51], v[112:127]
    v_exp_f32 v168, v168
    v_exp_f32 v169, v169
    v_exp_f32 v170, v170
    v_exp_f32 v171, v171
    v_cvt_pk_bf16_f32 v48, v168, v169
    v_cvt_pk_bf16_f32 v49, v170, v171
    s_waitcnt lgkmcnt(0)
    v_mfma_f32_32x32x16_bf16 v[96:111], v[40:43], v[44:47], v[96:111]
    ds_add_u32 v84, v85
    v_cmp_ge_u32 vcc, s52, v83
    s_add_u32 s52, s52, 1
    v_exp_f32 v172, v172
    v_exp_f32 v173, v173
    v_exp_f32 v174, v174
    v_exp_f32 v175, v175
    v_cvt_pk_bf16_f32 v50, v172, v173
    v_cvt_pk_bf16_f32 v51, v174, v175
    s_cbranch_vccnz GF_ASPIN0
    s_branch GF_AL0
GF_AEND:
    v_mov_b32 v82, 163008
    s_mov_b64 exec, 1
    ds_add_u32 v82, v85
    s_mov_b64 exec, -1
    v_mov_b32 v85, 64
    ds_add_u32 v84, v85
    v_exp_f32 v176, v176
    v_exp_f32 v177, v177
    v_exp_f32 v178, v178
    v_exp_f32 v179, v179
    v_cvt_pk_bf16_f32 v44, v176, v177
    v_cvt_pk_bf16_f32 v45, v178, v179
    v_exp_f32 v180, v180
    v_exp_f32 v181, v181
    v_exp_f32 v182, v182
    v_exp_f32 v183, v183
    v_cvt_pk_bf16_f32 v46, v180, v181
    v_cvt_pk_bf16_f32 v47, v182, v183
    v_mfma_f32_32x32x16_bf16 v[96:111], v[136:139], v[48:51], v[96:111]
    v_exp_f32 v184, v184
    v_exp_f32 v185, v185
    v_exp_f32 v186, v186
    v_exp_f32 v187, v187
    v_cvt_pk_bf16_f32 v48, v184, v185
    v_cvt_pk_bf16_f32 v49, v186, v187
    v_mfma_f32_32x32x16_bf16 v[112:127], v[40:43], v[44:47], v[112:127]
    v_exp_f32 v188, v188
    v_exp_f32 v189, v189
    v_exp_f32 v190, v190
    v_exp_f32 v191, v191
    v_cvt_pk_bf16_f32 v50, v188, v189
    v_cvt_pk_bf16_f32 v51, v190, v191
    s_nop 1
    v_mfma_f32_32x32x16_bf16 v[112:127], v[136:139], v[48:51], v[112:127]
    v_lshlrev_b32 v143, 4, v0
    v_lshlrev_b32 v144, 2, v1
    v_mul_u32_u24 v60, 18, v2
    v_add_u32 v60, v60, v1
    v_lshlrev_b32 v145, 4, v60
    s_add_u32 s5, s4, 2359296
    v_mov_b32 v59, 0x7b800000
    s_mov_b32 s52, 0
GF_GC:
    v_xor_b32 v60, v146, v149
    v_xor_b32 v61, v146, v151
    v_or_b32 v60, v60, v61
    v_cmp_ne_u32 vcc, 0, v60
    s_nop 1
    s_cbranch_vccz GF_GK
    s_sleep 4
    buffer_load_dwordx4 v[148:151], v7, s[36:39], s16 offen sc1
    s_add_u32 s52, s52, 1
    s_waitcnt vmcnt(0)
    s_cmp_lt_u32 s52, 0x8000
    s_cbranch_scc1 GF_GC
GF_GK:
    v_mov_b32 v61, 0xd800000
    v_add_f32 v58, abs(v96), abs(v97)
    v_add_f32 v58, v58, abs(v98)
    v_add_f32 v58, v58, abs(v99)
    v_add_f32 v58, v58, abs(v100)
    v_add_f32 v58, v58, abs(v101)
    v_add_f32 v58, v58, abs(v102)
    v_add_f32 v58, v58, abs(v103)
    v_cmp_gt_f32 s[50:51], v61, v58
    v_add_f32 v58, v58, abs(v104)
    v_add_f32 v58, v58, abs(v105)
    v_add_f32 v58, v58, abs(v106)
    v_cmp_nlt_f32 vcc, v58, v59
    s_nop 1
    s_or_b64 s[50:51], s[50:51], vcc
    s_cbranch_scc1 GF_EXACT0
GF_OK0:
    s_mov_b32 exec_lo, 0
    v_mov_b32 v106, v104
    s_mov_b64 exec, -1
    v_rcp_f32 v58, v106
    s_nop 0
    v_mul_f32 v58, v58, v148
    v_mul_f32 v96, v96, v58
    v_mul_f32 v97, v97, v58
    v_mul_f32 v98, v98, v58
    v_mul_f32 v99, v99, v58
    v_mul_f32 v100, v100, v58
    v_mul_f32 v101, v101, v58
    v_mul_f32 v102, v102, v58
    v_mul_f32 v103, v103, v58
    v_mul_f32 v104, v104, v58
    v_mul_f32 v105, v105, v58
    v_cvt_pk_bf16_f32 v176, v96, v97
    v_cvt_pk_bf16_f32 v177, v98, v99
    v_cvt_pk_bf16_f32 v178, v100, v101
    v_cvt_pk_bf16_f32 v179, v102, v103
    v_cvt_pk_bf16_f32 v180, v104, v105
    v_permlane32_swap_b32 v176, v178
    v_permlane32_swap_b32 v177, v179
    buffer_store_dwordx4 v[176:179], v143, s[36:39], s5 offen offset:0 sc1
    s_mov_b32 exec_hi, 0
    buffer_store_dword v180, v144, s[36:39], s5 offen offset:1024 sc1
    s_mov_b64 exec, -1
    v_mov_b32 v61, 0xd800000
    v_add_f32 v58, abs(v112), abs(v113)
    v_add_f32 v58, v58, abs(v114)
    v_add_f32 v58, v58, abs(v115)
    v_add_f32 v58, v58, abs(v116)
    v_add_f32 v58, v58, abs(v117)
    v_add_f32 v58, v58, abs(v118)
    v_add_f32 v58, v58, abs(v119)
    v_cmp_gt_f32 s[50:51], v61, v58
    v_add_f32 v58, v58, abs(v120)
    v_add_f32 v58, v58, abs(v121)
    v_add_f32 v58, v58, abs(v122)
    v_cmp_nlt_f32 vcc, v58, v59
    s_nop 1
    s_or_b64 s[50:51], s[50:51], vcc
    s_cbranch_scc1 GF_EXACT1
GF_OK1:
    s_mov_b32 exec_lo, 0
    v_mov_b32 v122, v120
    s_mov_b64 exec, -1
    v_rcp_f32 v58, v122
    s_nop 0
    v_mul_f32 v58, v58, v150
    v_mul_f32 v112, v112, v58
    v_mul_f32 v113, v113, v58
    v_mul_f32 v114, v114, v58
    v_mul_f32 v115, v115, v58
    v_mul_f32 v116, v116, v58
    v_mul_f32 v117, v117, v58
    v_mul_f32 v118, v118, v58
    v_mul_f32 v119, v119, v58
    v_mul_f32 v120, v120, v58
    v_mul_f32 v121, v121, v58
    v_cvt_pk_bf16_f32 v184, v112, v113
    v_cvt_pk_bf16_f32 v185, v114, v115
    v_cvt_pk_bf16_f32 v186, v116, v117
    v_cvt_pk_bf16_f32 v187, v118, v119
    v_cvt_pk_bf16_f32 v188, v120, v121
    v_permlane32_swap_b32 v184, v186
    v_permlane32_swap_b32 v185, v187
    buffer_store_dwordx4 v[184:187], v143, s[36:39], s5 offen offset:1152 sc1
    s_mov_b32 exec_hi, 0
    buffer_store_dword v188, v144, s[36:39], s5 offen offset:2176 sc1
    s_mov_b64 exec, -1
    s_setprio 0
    s_load_dwordx2 s[8:9], s[0:1], 32
    s_load_dwordx2 s[10:11], s[0:1], 72
    s_lshl_b32 s5, s3, 1
    s_add_u32 s5, s5, 41156608
    s_and_b32 s46, s2, 7
    s_lshr_b32 s48, s2, 3
    s_mul_i32 s46, s46, 30
    s_add_u32 s46, s46, s48
    s_cmp_ge_u32 s48, 30
    s_cselect_b32 s46, 999, s46
    s_mul_i32 s44, s46, 7282
    s_lshr_b32 s44, s44, 16
    s_mul_i32 s48, s44, 9
    s_sub_u32 s45, s46, s48
    s_mul_i32 s44, s44, 5
    s_min_u32 s44, s44, 123
    s_mov_b32 s53, 18432
    s_waitcnt vmcnt(0) lgkmcnt(0)
    s_mov_b64 exec, 1
    buffer_store_dword v146, v7, s[36:39], s5 offen sc1
    s_mov_b64 exec, -1
    s_mov_b32 s28, s8
    s_mov_b32 s29, s9
    s_mov_b32 s30, 663552
    s_mov_b32 s31, 0x00020000
    s_cmp_ge_u32 s46, 234
    s_cbranch_scc1 GF_END
    s_mov_b32 s50, 0
    s_cmp_ge_u32 s47, 2
    s_cbranch_scc1 G3_WL
    v_lshrrev_b32 v1, 3, v0
    v_and_b32 v2, 7, v0
    v_lshrrev_b32 v3, 1, v1
    v_xor_b32 v2, v2, v3
    s_lshl_b32 s3, s47, 2
    v_xor_b32 v2, s3, v2
    s_lshl_b32 s3, s44, 4
    s_mul_i32 s4, s47, 40
    s_add_u32 s3, s3, s4
    v_add_u32 v1, s3, v1
    v_mul_u32_u24 v1, 1152, v1
    v_lshlrev_b32 v2, 4, v2
    v_add_u32 v8, v1, v2
    v_xor_b32 v2, 64, v2
    v_add_u32 v9, v1, v2
    v_add_u32 v9, 9216, v9
    s_mov_b32 s54, 2359296
    s_mov_b32 s55, 2377728
    s_mov_b32 s56, 2396160
    s_mul_i32 s59, s47, 5120
    s_lshl_b32 s3, s3, 1
    s_add_u32 s3, s3, 41156608
    v_min_u32 v16, 19, v0
    v_lshlrev_b32 v16, 2, v16
    s_lshr_b32 s57, s44, 1
    s_lshl_b32 s57, s57, 6
    s_add_u32 s57, s57, 41209856
    v_min_u32 v17, 47, v0
    v_lshlrev_b32 v17, 2, v17
    v_lshrrev_b32 v1, 5, v0
    v_add_u32 v1, 0, v1
    v_cmp_lt_u32 vcc, 4, v1
    v_subrev_u32 v2, 5, v1
    s_nop 0
    v_cndmask_b32 v2, v1, v2, vcc
    v_cndmask_b32 v3, 0, 1, vcc
    v_add_u32 v2, s44, v2
    v_lshrrev_b32 v4, 1, v2
    v_mul_u32_u24 v4, 144, v4
    v_add_u32 v4, v4, v3
    v_lshlrev_b32 v4, 10, v4
    v_and_b32 v2, 1, v2
    v_lshl_add_u32 v4, v2, 9, v4
    v_and_b32 v2, 31, v0
    v_lshl_add_u32 v10, v2, 4, v4
    v_lshrrev_b32 v1, 5, v0
    v_add_u32 v1, 2, v1
    v_cmp_lt_u32 vcc, 4, v1
    v_subrev_u32 v2, 5, v1
    s_nop 0
    v_cndmask_b32 v2, v1, v2, vcc
    v_cndmask_b32 v3, 0, 1, vcc
    v_add_u32 v2, s44, v2
    v_lshrrev_b32 v4, 1, v2
    v_mul_u32_u24 v4, 144, v4
    v_add_u32 v4, v4, v3
    v_lshlrev_b32 v4, 10, v4
    v_and_b32 v2, 1, v2
    v_lshl_add_u32 v4, v2, 9, v4
    v_and_b32 v2, 31, v0
    v_lshl_add_u32 v11, v2, 4, v4
    v_lshrrev_b32 v1, 5, v0
    v_add_u32 v1, 4, v1
    v_cmp_lt_u32 vcc, 4, v1
    v_subrev_u32 v2, 5, v1
    s_nop 0
    v_cndmask_b32 v2, v1, v2, vcc
    v_cndmask_b32 v3, 0, 1, vcc
    v_add_u32 v2, s44, v2
    v_lshrrev_b32 v4, 1, v2
    v_mul_u32_u24 v4, 144, v4
    v_add_u32 v4, v4, v3
    v_lshlrev_b32 v4, 10, v4
    v_and_b32 v2, 1, v2
    v_lshl_add_u32 v4, v2, 9, v4
    v_and_b32 v2, 31, v0
    v_lshl_add_u32 v12, v2, 4, v4
    v_lshrrev_b32 v1, 5, v0
    v_add_u32 v1, 6, v1
    v_cmp_lt_u32 vcc, 4, v1
    v_subrev_u32 v2, 5, v1
    s_nop 0
    v_cndmask_b32 v2, v1, v2, vcc
    v_cndmask_b32 v3, 0, 1, vcc
    v_add_u32 v2, s44, v2
    v_lshrrev_b32 v4, 1, v2
    v_mul_u32_u24 v4, 144, v4
    v_add_u32 v4, v4, v3
    v_lshlrev_b32 v4, 10, v4
    v_and_b32 v2, 1, v2
    v_lshl_add_u32 v4, v2, 9, v4
    v_and_b32 v2, 31, v0
    v_lshl_add_u32 v13, v2, 4, v4
    v_lshrrev_b32 v1, 5, v0
    v_add_u32 v1, 8, v1
    v_cmp_lt_u32 vcc, 4, v1
    v_subrev_u32 v2, 5, v1
    s_nop 0
    v_cndmask_b32 v2, v1, v2, vcc
    v_cndmask_b32 v3, 0, 1, vcc
    v_add_u32 v2, s44, v2
    v_lshrrev_b32 v4, 1, v2
    v_mul_u32_u24 v4, 144, v4
    v_add_u32 v4, v4, v3
    v_lshlrev_b32 v4, 10, v4
    v_and_b32 v2, 1, v2
    v_lshl_add_u32 v4, v2, 9, v4
    v_and_b32 v2, 31, v0
    v_lshl_add_u32 v14, v2, 4, v4
    s_mov_b32 s62, 0
G3_OP:
    buffer_load_dword v18, v16, s[36:39], s3 offen sc1
    s_add_u32 s62, s62, 1
    s_waitcnt vmcnt(0)
    v_cmp_ne_u32 vcc, v146, v18
    s_nop 1
    s_cbranch_vccz G3_OPK
    s_sleep 16
    s_cmp_lt_u32 s62, 0x40000
    s_cbranch_scc1 G3_OP
G3_OPK:
    s_mov_b32 s52, 8
G3_TX:
    s_sleep 4
    ds_read_b32 v83, v82
    s_waitcnt lgkmcnt(0)
    v_cmp_gt_u32 vcc, s52, v83
    s_nop 1
    s_cbranch_vccnz G3_TX
    s_setprio 3
G3_TO:
    s_add_u32 m0, s50, s59
    s_nop 0
    buffer_load_dwordx4 v8, s[36:39], s54 offen sc1 lds
    s_add_u32 m0, m0, 1024
    s_nop 0
    buffer_load_dwordx4 v9, s[36:39], s54 offen sc1 lds
    s_add_u32 m0, m0, 1024
    s_add_u32 s54, s54, 128
    buffer_load_dwordx4 v8, s[36:39], s55 offen sc1 lds
    s_add_u32 m0, m0, 1024
    s_nop 0
    buffer_load_dwordx4 v9, s[36:39], s55 offen sc1 lds
    s_add_u32 m0, m0, 1024
    s_add_u32 s55, s55, 128
    buffer_load_dwordx4 v8, s[36:39], s56 offen sc1 lds
    s_add_u32 s56, s56, 128
    s_add_u32 s50, s50, s53
    s_cmp_eq_u32 s50, 147456
    s_cselect_b32 s50, 0, s50
    s_waitcnt vmcnt(10)
    s_sub_u32 s52, s52, 1
    s_cmp_lg_u32 s52, 0
    s_cbranch_scc1 G3_TO
    s_waitcnt vmcnt(35)
    s_barrier
    s_waitcnt vmcnt(30)
    s_barrier
    s_waitcnt vmcnt(25)
    s_barrier
    buffer_load_dword v18, v17, s[36:39], s57 offen sc1
    s_add_u32 m0, s50, s59
    s_nop 0
    buffer_load_dwordx4 v8, s[36:39], s54 offen sc1 lds
    s_add_u32 m0, m0, 1024
    s_nop 0
    buffer_load_dwordx4 v9, s[36:39], s54 offen sc1 lds
    s_add_u32 m0, m0, 1024
    s_add_u32 s54, s54, 128
    buffer_load_dwordx4 v8, s[36:39], s55 offen sc1 lds
    s_add_u32 m0, m0, 1024
    s_nop 0
    buffer_load_dwordx4 v9, s[36:39], s55 offen sc1 lds
    s_add_u32 m0, m0, 1024
    s_add_u32 s55, s55, 128
    buffer_load_dwordx4 v8, s[36:39], s56 offen sc1 lds
    s_add_u32 s56, s56, 128
    s_add_u32 s50, s50, s53
    s_cmp_eq_u32 s50, 147456
    s_cselect_b32 s50, 0, s50
    s_waitcnt vmcnt(25)
    s_barrier
    s_lshl_b32 s54, s47, 11
    s_add_u32 s54, s54, 24379392
    s_mov_b32 s62, 0
    s_waitcnt vmcnt(5)
G3_HP:
    v_cmp_ne_u32 vcc, v146, v18
    s_nop 1
    s_cbranch_vccz G3_HPK
    s_sleep 2
    buffer_load_dword v18, v17, s[36:39], s57 offen sc1
    s_add_u32 s62, s62, 1
    s_waitcnt vmcnt(0)
    s_cmp_lt_u32 s62, 0x40000
    s_cbranch_scc1 G3_HP
G3_HPK:
    s_mov_b32 s52, 36
G3_TH:
    s_add_u32 m0, s50, s59
    s_nop 0
    buffer_load_dwordx4 v10, s[36:39], s54 offen sc1 lds
    s_add_u32 m0, m0, 1024
    s_nop 0
    buffer_load_dwordx4 v11, s[36:39], s54 offen sc1 lds
    s_add_u32 m0, m0, 1024
    s_nop 0
    buffer_load_dwordx4 v12, s[36:39], s54 offen sc1 lds
    s_add_u32 m0, m0, 1024
    s_nop 0
    buffer_load_dwordx4 v13, s[36:39], s54 offen sc1 lds
    s_add_u32 m0, m0, 1024
    s_nop 0
    buffer_load_dwordx4 v14, s[36:39], s54 offen sc1 lds
    s_add_u32 s54, s54, 4096
    s_add_u32 s50, s50, s53
    s_cmp_eq_u32 s50, 147456
    s_cselect_b32 s50, 0, s50
    s_waitcnt vmcnt(25)
    s_barrier
    s_sub_u32 s52, s52, 1
    s_cmp_lg_u32 s52, 0
    s_cbranch_scc1 G3_TH
    s_waitcnt vmcnt(20)
    s_barrier
    s_waitcnt vmcnt(15)
    s_barrier
    s_waitcnt vmcnt(10)
    s_barrier
    s_waitcnt vmcnt(5)
    s_barrier
    s_waitcnt vmcnt(0)
    s_barrier
    s_waitcnt vmcnt(0)
    s_barrier
    s_endpgm
G3_WL:
    s_sub_u32 s47, s47, 2
    v_lshrrev_b32 v1, 3, v0
    v_and_b32 v2, 7, v0
    v_and_b32 v3, 6, v1
    v_xor_b32 v2, v2, v3
    v_lshlrev_b32 v2, 4, v2
    s_lshl_b32 s3, s45, 7
    v_add_u32 v2, s3, v2
    v_lshrrev_b32 v3, 2, v1
    v_and_b32 v4, 3, v1
    s_lshl_b32 s4, s47, 2
    v_add_u32 v5, s4, v3
    v_mul_u32_u24 v5, 18, v5
    v_add_u32 v5, v5, v4
    v_mul_u32_u24 v5, 1152, v5
    v_add_u32 v8, v2, v5
    v_add_u32 v9, 41472, v8
    v_add_u32 v10, 4608, v8
    v_add_u32 v11, 46080, v8
    s_lshl_b32 s4, s47, 4
    v_lshl_add_u32 v5, v3, 2, s4
    v_lshrrev_b32 v6, 1, v4
    v_add_u32 v5, v5, v6
    v_mul_u32_u24 v5, 18, v5
    v_and_b32 v6, 1, v4
    v_add3_u32 v5, v5, v6, 16
    v_mul_u32_u24 v5, 1152, v5
    v_add_u32 v12, v2, v5
    s_mov_b32 s55, 0
    s_mov_b32 s56, 0
    s_lshl_b32 s59, s47, 12
    s_add_u32 s59, s59, 10240
    s_waitcnt vmcnt(0)
    s_mov_b32 s52, 8
G3_WX:
    s_sleep 4
    ds_read_b32 v83, v82
    s_waitcnt lgkmcnt(0)
    v_cmp_gt_u32 vcc, s52, v83
    s_nop 1
    s_cbranch_vccnz G3_WX
    s_setprio 3
G3_WO:
    s_add_u32 m0, s50, s59
    s_nop 0
    buffer_load_dwordx4 v8, s[28:31], s55 offen lds
    s_add_u32 m0, m0, 1024
    s_nop 0
    buffer_load_dwordx4 v9, s[28:31], s55 offen lds
    s_add_u32 m0, m0, 1024
    s_nop 0
    buffer_load_dwordx4 v10, s[28:31], s55 offen lds
    s_add_u32 m0, m0, 1024
    s_nop 0
    buffer_load_dwordx4 v11, s[28:31], s55 offen lds
    s_add_u32 s55, s55, 165888
    s_add_u32 s56, s56, 1
    s_cmp_eq_u32 s56, 4
    s_cselect_b32 s55, 9216, s55
    s_add_u32 s50, s50, s53
    s_cmp_eq_u32 s50, 147456
    s_cselect_b32 s50, 0, s50
    s_waitcnt vmcnt(8)
    s_sub_u32 s52, s52, 1
    s_cmp_lg_u32 s52, 0
    s_cbranch_scc1 G3_WO
    s_waitcnt vmcnt(28)
    s_barrier
    s_waitcnt vmcnt(24)
    s_barrier
    s_waitcnt vmcnt(20)
    s_barrier
    v_mov_b32 v8, v12
    v_add_u32 v9, 165888, v12
    v_add_u32 v10, 41472, v12
    v_add_u32 v11, 207360, v12
    s_mov_b32 s55, 0
    s_add_u32 m0, s50, s59
    s_nop 0
    buffer_load_dwordx4 v8, s[28:31], s55 offen lds
    s_add_u32 m0, m0, 1024
    s_nop 0
    buffer_load_dwordx4 v9, s[28:31], s55 offen lds
    s_add_u32 m0, m0, 1024
    s_nop 0
    buffer_load_dwordx4 v10, s[28:31], s55 offen lds
    s_add_u32 m0, m0, 1024
    s_nop 0
    buffer_load_dwordx4 v11, s[28:31], s55 offen lds
    s_add_u32 s55, s55, 165888
    s_add_u32 s56, s56, 1
    s_cmp_eq_u32 s56, 4
    s_cselect_b32 s55, 9216, s55
    s_add_u32 s50, s50, s53
    s_cmp_eq_u32 s50, 147456
    s_cselect_b32 s50, 0, s50
    s_waitcnt vmcnt(20)
    s_barrier
    s_mov_b32 s28, s10
    s_mov_b32 s29, s11
    s_mov_b32 s30, 2654208
    s_mov_b32 s31, 0x00020000
    s_lshl_b32 s4, s47, 5
    v_add_u32 v3, s4, v1
    v_mul_u32_u24 v3, 1152, v3
    v_add_u32 v8, v2, v3
    v_add_u32 v9, 9216, v8
    v_add_u32 v10, 18432, v8
    v_add_u32 v11, 27648, v8
    s_mov_b32 s55, 0
    s_mov_b32 s52, 36
G3_WH:
    s_add_u32 m0, s50, s59
    s_nop 0
    buffer_load_dwordx4 v8, s[28:31], s55 offen lds
    s_add_u32 m0, m0, 1024
    s_nop 0
    buffer_load_dwordx4 v9, s[28:31], s55 offen lds
    s_add_u32 m0, m0, 1024
    s_nop 0
    buffer_load_dwordx4 v10, s[28:31], s55 offen lds
    s_add_u32 m0, m0, 1024
    s_nop 0
    buffer_load_dwordx4 v11, s[28:31], s55 offen lds
    s_add_u32 s55, s55, 73728
    s_add_u32 s50, s50, s53
    s_cmp_eq_u32 s50, 147456
    s_cselect_b32 s50, 0, s50
    s_waitcnt vmcnt(20)
    s_barrier
    s_sub_u32 s52, s52, 1
    s_cmp_lg_u32 s52, 0
    s_cbranch_scc1 G3_WH
    s_waitcnt vmcnt(16)
    s_barrier
    s_waitcnt vmcnt(12)
    s_barrier
    s_waitcnt vmcnt(8)
    s_barrier
    s_waitcnt vmcnt(4)
    s_barrier
    s_waitcnt vmcnt(0)
    s_barrier
    s_waitcnt vmcnt(0)
    s_barrier
    s_endpgm
GF_EXACT0:
    v_mov_b32 v13, 0
    v_mov_b32 v14, 0
    v_mov_b32 v58, 0xff800000
    s_mov_b32 s52, 0
GF_FM0:
    s_add_u32 s7, s52, 1
    s_lshr_b32 s6, s7, 1
    s_and_b32 s7, s7, 1
    s_mul_i32 s6, s6, 4608
    s_add_u32 s6, s6, 4718592
    s_mul_i32 s7, s7, 1152
    s_add_u32 s6, s6, s7
    s_lshr_b32 s7, s52, 1
    s_mul_i32 s7, s7, 4608
    s_and_b32 s15, s52, 1
    s_mul_i32 s15, s15, 1152
    s_add_u32 s7, s7, s15
    s_add_u32 s7, s7, 4725504
    buffer_load_dwordx4 v[24:27], v143, s[36:39], s6 offen sc1
    buffer_load_dword v28, v144, s[36:39], s6 offen offset:1024 sc1
    s_waitcnt vmcnt(0)
    v_mfma_f32_32x32x16_bf16 v[160:175], v[24:27], v[8:11], 0
    v_mfma_f32_32x32x16_bf16 v[160:175], v[28:31], v[12:15], v[160:175]
    s_nop 11
    v_max3_f32 v58, v58, v160, v161
    v_max3_f32 v58, v58, v162, v163
    v_max3_f32 v58, v58, v164, v165
    v_max3_f32 v58, v58, v166, v167
    v_max3_f32 v58, v58, v168, v169
    v_max3_f32 v58, v58, v170, v171
    v_max3_f32 v58, v58, v172, v173
    v_max3_f32 v58, v58, v174, v175
    s_add_u32 s52, s52, 1
    s_cmp_lt_u32 s52, 64
    s_cbranch_scc1 GF_FM0
    v_mov_b32 v60, v58
    s_nop 1
    v_permlane32_swap_b32 v58, v60
    v_max_f32 v58, v58, v60
    v_sub_f32 v58, 0x80000000, v58
    v_cvt_pk_bf16_f32 v60, v58, v58
    v_and_b32 v60, 0xffff0000, v60
    v_sub_f32 v58, v58, v60
    v_cvt_pk_bf16_f32 v61, v58, v58
    v_and_b32 v61, 0xffff0000, v61
    v_sub_f32 v58, v58, v61
    v_lshrrev_b32 v60, 16, v60
    s_mov_b32 exec_hi, 0
    v_or_b32 v13, v60, v61
    v_cvt_pk_bf16_f32 v14, v58, v7
    s_mov_b64 exec, -1
    v_mov_b32 v96, 0
    v_mov_b32 v97, 0
    v_mov_b32 v98, 0
    v_mov_b32 v99, 0
    v_mov_b32 v100, 0
    v_mov_b32 v101, 0
    v_mov_b32 v102, 0
    v_mov_b32 v103, 0
    v_mov_b32 v104, 0
    v_mov_b32 v105, 0
    v_mov_b32 v106, 0
    v_mov_b32 v107, 0
    v_mov_b32 v108, 0
    v_mov_b32 v109, 0
    v_mov_b32 v110, 0
    v_mov_b32 v111, 0
    s_mov_b32 s52, 0
GF_FP0:
    s_add_u32 s7, s52, 1
    s_lshr_b32 s6, s7, 1
    s_and_b32 s7, s7, 1
    s_mul_i32 s6, s6, 4608
    s_add_u32 s6, s6, 4718592
    s_mul_i32 s7, s7, 1152
    s_add_u32 s6, s6, s7
    s_lshr_b32 s7, s52, 1
    s_mul_i32 s7, s7, 4608
    s_and_b32 s15, s52, 1
    s_mul_i32 s15, s15, 1152
    s_add_u32 s7, s7, s15
    s_add_u32 s7, s7, 4725504
    buffer_load_dwordx4 v[24:27], v143, s[36:39], s6 offen sc1
    buffer_load_dword v28, v144, s[36:39], s6 offen offset:1024 sc1
    s_mov_b64 exec, s[62:63]
    buffer_load_dwordx4 v[32:35], v145, s[36:39], s7 offen sc1
    buffer_load_dwordx4 v[36:39], v145, s[36:39], s7 offen offset:576 sc1
    s_mov_b64 exec, -1
    s_waitcnt vmcnt(0)
    v_mfma_f32_32x32x16_bf16 v[160:175], v[24:27], v[8:11], 0
    v_mfma_f32_32x32x16_bf16 v[160:175], v[28:31], v[12:15], v[160:175]
    s_nop 11
    v_exp_f32 v160, v160
    v_exp_f32 v161, v161
    v_exp_f32 v162, v162
    v_exp_f32 v163, v163
    v_cvt_pk_bf16_f32 v44, v160, v161
    v_cvt_pk_bf16_f32 v45, v162, v163
    v_exp_f32 v164, v164
    v_exp_f32 v165, v165
    v_exp_f32 v166, v166
    v_exp_f32 v167, v167
    v_cvt_pk_bf16_f32 v46, v164, v165
    v_cvt_pk_bf16_f32 v47, v166, v167
    v_exp_f32 v168, v168
    v_exp_f32 v169, v169
    v_exp_f32 v170, v170
    v_exp_f32 v171, v171
    v_cvt_pk_bf16_f32 v48, v168, v169
    v_cvt_pk_bf16_f32 v49, v170, v171
    v_exp_f32 v172, v172
    v_exp_f32 v173, v173
    v_exp_f32 v174, v174
    v_exp_f32 v175, v175
    v_cvt_pk_bf16_f32 v50, v172, v173
    v_cvt_pk_bf16_f32 v51, v174, v175
    v_mfma_f32_32x32x16_bf16 v[96:111], v[32:35], v[44:47], v[96:111]
    s_nop 0
    v_mfma_f32_32x32x16_bf16 v[96:111], v[36:39], v[48:51], v[96:111]
    s_add_u32 s52, s52, 1
    s_cmp_lt_u32 s52, 64
    s_nop 8
    s_cbranch_scc1 GF_FP0
    s_nop 4
    s_branch GF_OK0
GF_EXACT1:
    v_mov_b32 v21, 0
    v_mov_b32 v22, 0
    v_mov_b32 v58, 0xff800000
    s_mov_b32 s52, 0
GF_FM1:
    s_add_u32 s7, s52, 1
    s_lshr_b32 s6, s7, 1
    s_and_b32 s7, s7, 1
    s_mul_i32 s6, s6, 4608
    s_add_u32 s6, s6, 4718592
    s_mul_i32 s7, s7, 1152
    s_add_u32 s6, s6, s7
    s_lshr_b32 s7, s52, 1
    s_mul_i32 s7, s7, 4608
    s_and_b32 s15, s52, 1
    s_mul_i32 s15, s15, 1152
    s_add_u32 s7, s7, s15
    s_add_u32 s7, s7, 4725504
    buffer_load_dwordx4 v[24:27], v143, s[36:39], s6 offen sc1
    buffer_load_dword v28, v144, s[36:39], s6 offen offset:1024 sc1
    s_waitcnt vmcnt(0)
    v_mfma_f32_32x32x16_bf16 v[160:175], v[24:27], v[16:19], 0
    v_mfma_f32_32x32x16_bf16 v[160:175], v[28:31], v[20:23], v[160:175]
    s_nop 11
    v_max3_f32 v58, v58, v160, v161
    v_max3_f32 v58, v58, v162, v163
    v_max3_f32 v58, v58, v164, v165
    v_max3_f32 v58, v58, v166, v167
    v_max3_f32 v58, v58, v168, v169
    v_max3_f32 v58, v58, v170, v171
    v_max3_f32 v58, v58, v172, v173
    v_max3_f32 v58, v58, v174, v175
    s_add_u32 s52, s52, 1
    s_cmp_lt_u32 s52, 64
    s_cbranch_scc1 GF_FM1
    v_mov_b32 v60, v58
    s_nop 1
    v_permlane32_swap_b32 v58, v60
    v_max_f32 v58, v58, v60
    v_sub_f32 v58, 0x80000000, v58
    v_cvt_pk_bf16_f32 v60, v58, v58
    v_and_b32 v60, 0xffff0000, v60
    v_sub_f32 v58, v58, v60
    v_cvt_pk_bf16_f32 v61, v58, v58
    v_and_b32 v61, 0xffff0000, v61
    v_sub_f32 v58, v58, v61
    v_lshrrev_b32 v60, 16, v60
    s_mov_b32 exec_hi, 0
    v_or_b32 v21, v60, v61
    v_cvt_pk_bf16_f32 v22, v58, v7
    s_mov_b64 exec, -1
    v_mov_b32 v112, 0
    v_mov_b32 v113, 0
    v_mov_b32 v114, 0
    v_mov_b32 v115, 0
    v_mov_b32 v116, 0
    v_mov_b32 v117, 0
    v_mov_b32 v118, 0
    v_mov_b32 v119, 0
    v_mov_b32 v120, 0
    v_mov_b32 v121, 0
    v_mov_b32 v122, 0
    v_mov_b32 v123, 0
    v_mov_b32 v124, 0
    v_mov_b32 v125, 0
    v_mov_b32 v126, 0
    v_mov_b32 v127, 0
    s_mov_b32 s52, 0
GF_FP1:
    s_add_u32 s7, s52, 1
    s_lshr_b32 s6, s7, 1
    s_and_b32 s7, s7, 1
    s_mul_i32 s6, s6, 4608
    s_add_u32 s6, s6, 4718592
    s_mul_i32 s7, s7, 1152
    s_add_u32 s6, s6, s7
    s_lshr_b32 s7, s52, 1
    s_mul_i32 s7, s7, 4608
    s_and_b32 s15, s52, 1
    s_mul_i32 s15, s15, 1152
    s_add_u32 s7, s7, s15
    s_add_u32 s7, s7, 4725504
    buffer_load_dwordx4 v[24:27], v143, s[36:39], s6 offen sc1
    buffer_load_dword v28, v144, s[36:39], s6 offen offset:1024 sc1
    s_mov_b64 exec, s[62:63]
    buffer_load_dwordx4 v[32:35], v145, s[36:39], s7 offen sc1
    buffer_load_dwordx4 v[36:39], v145, s[36:39], s7 offen offset:576 sc1
    s_mov_b64 exec, -1
    s_waitcnt vmcnt(0)
    v_mfma_f32_32x32x16_bf16 v[160:175], v[24:27], v[16:19], 0
    v_mfma_f32_32x32x16_bf16 v[160:175], v[28:31], v[20:23], v[160:175]
    s_nop 11
    v_exp_f32 v160, v160
    v_exp_f32 v161, v161
    v_exp_f32 v162, v162
    v_exp_f32 v163, v163
    v_cvt_pk_bf16_f32 v44, v160, v161
    v_cvt_pk_bf16_f32 v45, v162, v163
    v_exp_f32 v164, v164
    v_exp_f32 v165, v165
    v_exp_f32 v166, v166
    v_exp_f32 v167, v167
    v_cvt_pk_bf16_f32 v46, v164, v165
    v_cvt_pk_bf16_f32 v47, v166, v167
    v_exp_f32 v168, v168
    v_exp_f32 v169, v169
    v_exp_f32 v170, v170
    v_exp_f32 v171, v171
    v_cvt_pk_bf16_f32 v48, v168, v169
    v_cvt_pk_bf16_f32 v49, v170, v171
    v_exp_f32 v172, v172
    v_exp_f32 v173, v173
    v_exp_f32 v174, v174
    v_exp_f32 v175, v175
    v_cvt_pk_bf16_f32 v50, v172, v173
    v_cvt_pk_bf16_f32 v51, v174, v175
    v_mfma_f32_32x32x16_bf16 v[112:127], v[32:35], v[44:47], v[112:127]
    s_nop 0
    v_mfma_f32_32x32x16_bf16 v[112:127], v[36:39], v[48:51], v[112:127]
    s_add_u32 s52, s52, 1
    s_cmp_lt_u32 s52, 64
    s_nop 8
    s_cbranch_scc1 GF_FP1
    s_nop 4
    s_branch GF_OK1
GF_END:
    s_endpgm
CODE_END:
    s_endpgm
.section .rodata,"a"
.p2align 6
.amdhsa_kernel gated_mix__grouped_kv_mqa__mixer_gmlp__prompt_kernel
  .amdhsa_next_free_vgpr 256
  .amdhsa_next_free_sgpr 96
  .amdhsa_accum_offset 256
  .amdhsa_group_segment_fixed_size 0
  .amdhsa_kernarg_size 112
  .amdhsa_user_sgpr_count 2
  .amdhsa_user_sgpr_kernarg_segment_ptr 1
  .amdhsa_system_sgpr_workgroup_id_x 1
.end_amdhsa_kernel
```
